```python
import torch

def _softmax(x, axis=-1):
    return torch.softmax(x, dim=axis)
def _gelu(x):
    return torch.nn.functional.gelu(x, approximate="tanh")
def _silu(x):
    return torch.nn.functional.silu(x)
def _sigmoid(x):
    return torch.sigmoid(x)
def _layernorm(x, axis=-1, eps=1e-5):
    m = x.mean(dim=axis, keepdim=True)
    v = x.var(dim=axis, keepdim=True, unbiased=False)
    return (x - m) / torch.sqrt(v + eps)
def _scatter_add(tgt, idx, src, axis=0):
    return tgt.clone().index_add_(axis, idx, src)
def _segment_sum(src, seg, n):
    out = torch.zeros((n,) + src.shape[1:], dtype=src.dtype)
    return out.index_add_(0, seg, src)
def _pad(x, pw):
    flat = tuple(v for pair in reversed(pw) for v in pair)
    return torch.nn.functional.pad(x, flat)

kernel_name = 'standalone__modern_conv_block_convnext_v2__vision'

def setup_inputs():

    _w = (lambda a: (lambda t: t.to(torch.bfloat16) if t.is_floating_point() else t)(torch.as_tensor(a)))
    H = W = 224
    C = 96
    K = 7
    return {
        "x": _w((lambda *s: torch.randn(*s, dtype=torch.bfloat16) * 0.05)(1, H, W, C)),
        "dw": _w((lambda *s: torch.randn(*s, dtype=torch.bfloat16) * 0.05)(K, K, C)),
        "w1": _w((lambda *s: torch.randn(*s, dtype=torch.bfloat16) * 0.05)(C, 4 * C)),
        "w2": _w((lambda *s: torch.randn(*s, dtype=torch.bfloat16) * 0.05)(4 * C, C)),
        "grn_gamma": _w((lambda *s: torch.randn(*s, dtype=torch.bfloat16) * 0.05)(4 * C)),
        "grn_beta": _w((lambda *s: torch.randn(*s, dtype=torch.bfloat16) * 0.05)(4 * C)),
    }

def reference(x, dw, w1, w2, grn_gamma, grn_beta):
    B, H, W, C = x.shape
    K = dw.shape[0]
    pad = K // 2
    xp = _pad(x, ((0,0),(pad,pad),(pad,pad),(0,0)))
    out = torch.zeros_like(x)
    for i in range(K):
        for j in range(K):
            out = out + xp[:, i:i+H, j:j+W, :] * dw[i, j][None, None, None, :]
    h = _layernorm(out, axis=-1)
    h = torch.einsum('bhwc,ce->bhwe', h, w1)
    h = _gelu(h)
    gx = torch.sqrt((h * h).sum(axis=(1, 2), keepdims=True) + 1e-6)
    nx = gx / (gx.mean(axis=-1, keepdims=True) + 1e-6)
    h = grn_gamma * (h * nx) + grn_beta + h
    h = torch.einsum('bhwe,ec->bhwc', h, w2)
    return x + h
```

```asm
; @launch grid=(256,1,1) block=(512,1,1) lds=163840
.amdgcn_target "amdgcn-amd-amdhsa--gfx950"
.text
.globl standalone__modern_conv_block_convnext_v2__vision_kernel
.p2align 8
.type standalone__modern_conv_block_convnext_v2__vision_kernel,@function
standalone__modern_conv_block_convnext_v2__vision_kernel:
    s_cmp_ge_u32 s2, 256
    s_cbranch_scc1 L_end
    s_load_dwordx16 s[4:19], s[0:1], 0
    s_load_dwordx2 s[20:21], s[0:1], 64
    v_and_b32 v1, 63, v0
    v_lshrrev_b32 v2, 6, v0
    s_nop 0
    v_readfirstlane_b32 s60, v2
    s_and_b32 s70, s2, 7
    s_lshr_b32 s71, s2, 3
    s_lshr_b32 s72, s70, 1
    s_lshl_b32 s72, s72, 2
    s_lshr_b32 s73, s71, 3
    s_add_u32 s72, s72, s73
    s_and_b32 s73, s70, 1
    s_lshl_b32 s73, s73, 3
    s_and_b32 s74, s71, 7
    s_add_u32 s73, s73, s74
    s_mul_i32 s64, s73, 14
    s_mul_i32 s72, s72, 14*224
    s_add_u32 s72, s72, s64
    s_mul_i32 s61, s72, 192
    s_and_b32 s62, s60, 3
    s_lshr_b32 s63, s60, 2
    s_mov_b32 s66, 0xffff0000
    s_mov_b32 s68, 1084043516
    s_mov_b32 s69, 1084043516
    s_mov_b32 s70, 0x15555556
    s_mov_b32 s71, 0x33333334
    s_sub_u32 s72, s61, 129600
    s_sub_u32 s73, s64, 3
    v_add_u32 v2, 0, v0
    v_mul_hi_u32 v3, v2, s70
    v_mul_u32_u24 v4, 12, v3
    v_sub_u32 v4, v2, v4
    v_mul_hi_u32 v5, v3, s71
    v_mul_u32_u24 v6, 5, v5
    v_sub_u32 v6, v3, v6
    v_mul_u32_u24 v7, 7696, v4
    v_mul_u32_u24 v8, 48, v5
    v_add_u32 v7, v7, v8
    v_lshl_add_u32 v10, v6, 3, v7
    v_mul_u32_u24 v7, 224*192, v5
    v_mul_u32_u24 v8, 768, v6
    v_add3_u32 v7, v7, v8, s72
    v_lshl_add_u32 v7, v4, 4, v7
    v_lshl_add_u32 v8, v6, 2, s73
    v_mov_b32 v9, 0x7fffff00
    v_add_u32 v13, 0, v8
    v_add_u32 v14, 0, v7
    v_cmp_gt_u32 vcc, 224, v13
    s_nop 1
    v_cndmask_b32 v64, v9, v14, vcc
    v_add_u32 v13, 1, v8
    v_add_u32 v14, 192, v7
    v_cmp_gt_u32 vcc, 224, v13
    s_nop 1
    v_cndmask_b32 v65, v9, v14, vcc
    v_add_u32 v13, 2, v8
    v_add_u32 v14, 384, v7
    v_cmp_gt_u32 vcc, 224, v13
    s_nop 1
    v_cndmask_b32 v66, v9, v14, vcc
    v_add_u32 v13, 3, v8
    v_add_u32 v14, 576, v7
    v_cmp_gt_u32 vcc, 224, v13
    s_nop 1
    v_cndmask_b32 v67, v9, v14, vcc
    v_add_u32 v2, 512, v0
    v_mul_hi_u32 v3, v2, s70
    v_mul_u32_u24 v4, 12, v3
    v_sub_u32 v4, v2, v4
    v_mul_hi_u32 v5, v3, s71
    v_mul_u32_u24 v6, 5, v5
    v_sub_u32 v6, v3, v6
    v_mul_u32_u24 v7, 7696, v4
    v_mul_u32_u24 v8, 48, v5
    v_add_u32 v7, v7, v8
    v_lshl_add_u32 v11, v6, 3, v7
    v_mul_u32_u24 v7, 224*192, v5
    v_mul_u32_u24 v8, 768, v6
    v_add3_u32 v7, v7, v8, s72
    v_lshl_add_u32 v7, v4, 4, v7
    v_lshl_add_u32 v8, v6, 2, s73
    v_mov_b32 v9, 0x7fffff00
    v_add_u32 v13, 0, v8
    v_add_u32 v14, 0, v7
    v_cmp_gt_u32 vcc, 224, v13
    s_nop 1
    v_cndmask_b32 v68, v9, v14, vcc
    v_add_u32 v13, 1, v8
    v_add_u32 v14, 192, v7
    v_cmp_gt_u32 vcc, 224, v13
    s_nop 1
    v_cndmask_b32 v69, v9, v14, vcc
    v_add_u32 v13, 2, v8
    v_add_u32 v14, 384, v7
    v_cmp_gt_u32 vcc, 224, v13
    s_nop 1
    v_cndmask_b32 v70, v9, v14, vcc
    v_add_u32 v13, 3, v8
    v_add_u32 v14, 576, v7
    v_cmp_gt_u32 vcc, 224, v13
    s_nop 1
    v_cndmask_b32 v71, v9, v14, vcc
    v_add_u32 v2, 1024, v0
    v_mul_hi_u32 v3, v2, s70
    v_mul_u32_u24 v4, 12, v3
    v_sub_u32 v4, v2, v4
    v_mul_hi_u32 v5, v3, s71
    v_mul_u32_u24 v6, 5, v5
    v_sub_u32 v6, v3, v6
    v_mul_u32_u24 v7, 7696, v4
    v_mul_u32_u24 v8, 48, v5
    v_add_u32 v7, v7, v8
    v_lshl_add_u32 v12, v6, 3, v7
    v_mul_u32_u24 v7, 224*192, v5
    v_mul_u32_u24 v8, 768, v6
    v_add3_u32 v7, v7, v8, s72
    v_lshl_add_u32 v7, v4, 4, v7
    v_lshl_add_u32 v8, v6, 2, s73
    v_mov_b32 v9, -8
    v_cmp_gt_u32 vcc, 1200, v2
    s_nop 1
    v_cndmask_b32 v8, v9, v8, vcc
    v_mov_b32 v9, 0x7fffff00
    v_add_u32 v13, 0, v8
    v_add_u32 v14, 0, v7
    v_cmp_gt_u32 vcc, 224, v13
    s_nop 1
    v_cndmask_b32 v72, v9, v14, vcc
    v_add_u32 v13, 1, v8
    v_add_u32 v14, 192, v7
    v_cmp_gt_u32 vcc, 224, v13
    s_nop 1
    v_cndmask_b32 v73, v9, v14, vcc
    v_add_u32 v13, 2, v8
    v_add_u32 v14, 384, v7
    v_cmp_gt_u32 vcc, 224, v13
    s_nop 1
    v_cndmask_b32 v74, v9, v14, vcc
    v_add_u32 v13, 3, v8
    v_add_u32 v14, 576, v7
    v_cmp_gt_u32 vcc, 224, v13
    s_nop 1
    v_cndmask_b32 v75, v9, v14, vcc
    v_mov_b32 v80, -1
    v_mov_b32 v81, -1
    v_mov_b32 v82, -1
    v_mov_b32 v83, -1
    s_lshl_b32 s70, s2, 12
    v_lshl_add_u32 v3, v0, 4, s70
    s_lshl_b32 s70, s2, 4
    s_add_u32 s70, s70, 983040
    v_mul_u32_u24 v8, 4352, v0
    v_add_u32 v8, s70, v8
    v_cmp_le_u32 vcc, 0x100, v0
    s_nop 1
    v_cndmask_b32 v78, v3, v8, vcc
    v_mov_b32 v76, 0
    v_mov_b32 v77, 0
    v_mov_b32 v79, 0
    v_mov_b32 v15, 0
    v_mov_b32 v133, 0
    s_cmp_lg_u32 s63, 0
    s_cbranch_scc1 L_yng
    s_mov_b32 s70, 0x05555556
    v_add_u32 v2, 0, v0
    v_mul_hi_u32 v3, v2, s70
    v_mul_u32_u24 v4, 48, v3
    v_sub_u32 v4, v2, v4
    v_mul_u32_u24 v5, 1344, v3
    v_lshl_add_u32 v76, v4, 2, v5
    v_mul_u32_u24 v4, 1136, v4
    v_mul_u32_u24 v3, 80, v3
    v_add_u32 v4, v4, v3
    v_add_u32 v15, 92352, v4
    v_add_u32 v2, 256, v0
    v_mul_hi_u32 v3, v2, s70
    v_mul_u32_u24 v4, 48, v3
    v_sub_u32 v4, v2, v4
    v_mul_u32_u24 v5, 1344, v3
    v_lshl_add_u32 v77, v4, 2, v5
    v_mul_u32_u24 v4, 1136, v4
    v_mul_u32_u24 v3, 80, v3
    v_add_u32 v4, v4, v3
    v_add_u32 v133, 92352, v4
    s_branch L_kw
L_yng:
    s_lshr_b32 s70, s2, 3
    s_mul_i32 s70, s70, 2304
    v_min_u32 v79, 17, v1
    v_lshl_add_u32 v79, v79, 7, s70
L_kw:
    s_waitcnt lgkmcnt(0)
    s_mov_b32 s24, s4
    s_and_b32 s25, s5, 0xffff
    s_mov_b32 s26, 9633792
    s_mov_b32 s27, 0x20000
    s_mov_b32 s56, s20
    s_and_b32 s57, s21, 0xffff
    s_mov_b32 s58, 2166784
    s_mov_b32 s59, 0x20000
    s_cmp_ge_u32 s2, 96
    s_cbranch_scc1 L_noclear
    buffer_store_dwordx4 v[80:83], v78, s[56:59], 0 offen sc1
L_noclear:
    s_cmp_lg_u32 s63, 0
    s_cbranch_scc1 L_yng2
    s_mov_b32 s28, s6
    s_and_b32 s29, s7, 0xffff
    s_mov_b32 s30, 9408
    s_mov_b32 s31, 0x20000
    buffer_load_dword v100, v76, s[28:31], 0 offen offset:0
    buffer_load_dword v101, v76, s[28:31], 0 offen offset:192
    buffer_load_dword v102, v76, s[28:31], 0 offen offset:384
    buffer_load_dword v103, v76, s[28:31], 0 offen offset:576
    buffer_load_dword v104, v76, s[28:31], 0 offen offset:768
    buffer_load_dword v105, v76, s[28:31], 0 offen offset:960
    buffer_load_dword v106, v76, s[28:31], 0 offen offset:1152
    s_cmp_ge_u32 s60, 2
    s_cbranch_scc1 L_loads
    buffer_load_dword v107, v77, s[28:31], 0 offen offset:0
    buffer_load_dword v108, v77, s[28:31], 0 offen offset:192
    buffer_load_dword v109, v77, s[28:31], 0 offen offset:384
    buffer_load_dword v110, v77, s[28:31], 0 offen offset:576
    buffer_load_dword v111, v77, s[28:31], 0 offen offset:768
    buffer_load_dword v112, v77, s[28:31], 0 offen offset:960
    buffer_load_dword v113, v77, s[28:31], 0 offen offset:1152
    s_branch L_loads
L_yng2:
    s_cmp_lg_u32 s60, 7
    s_cbranch_scc1 L_loads
    s_mov_b32 s32, s8
    s_and_b32 s33, s9, 0xffff
    s_mov_b32 s34, 73728
    s_mov_b32 s35, 0x20000
    s_mov_b32 s36, s10
    s_and_b32 s37, s11, 0xffff
    s_mov_b32 s38, 73728
    s_mov_b32 s39, 0x20000
    buffer_load_dword v134, v79, s[32:35], 0 offen
    buffer_load_dword v135, v79, s[36:39], 0 offen
L_loads:
    buffer_load_dwordx4 v[16:19], v64, s[24:27], 0 offen
    buffer_load_dwordx4 v[20:23], v65, s[24:27], 0 offen
    buffer_load_dwordx4 v[24:27], v66, s[24:27], 0 offen
    buffer_load_dwordx4 v[28:31], v67, s[24:27], 0 offen
    buffer_load_dwordx4 v[32:35], v68, s[24:27], 0 offen
    buffer_load_dwordx4 v[36:39], v69, s[24:27], 0 offen
    buffer_load_dwordx4 v[40:43], v70, s[24:27], 0 offen
    buffer_load_dwordx4 v[44:47], v71, s[24:27], 0 offen
    buffer_load_dwordx4 v[48:51], v72, s[24:27], 0 offen
    buffer_load_dwordx4 v[52:55], v73, s[24:27], 0 offen
    buffer_load_dwordx4 v[56:59], v74, s[24:27], 0 offen
    buffer_load_dwordx4 v[60:63], v75, s[24:27], 0 offen
    s_mov_b32 s28, s6
    s_and_b32 s29, s7, 0xffff
    s_mov_b32 s30, 9408
    s_mov_b32 s31, 0x20000
    s_mov_b32 s32, s8
    s_and_b32 s33, s9, 0xffff
    s_mov_b32 s34, 73728
    s_mov_b32 s35, 0x20000
    s_mov_b32 s36, s10
    s_and_b32 s37, s11, 0xffff
    s_mov_b32 s38, 73728
    s_mov_b32 s39, 0x20000
    s_mov_b32 s40, s12
    s_and_b32 s41, s13, 0xffff
    s_mov_b32 s42, 768
    s_mov_b32 s43, 0x20000
    s_mov_b32 s44, s14
    s_and_b32 s45, s15, 0xffff
    s_mov_b32 s46, 768
    s_mov_b32 s47, 0x20000
    s_mov_b32 s48, s16
    s_and_b32 s49, s17, 0xffff
    s_mov_b32 s50, 9633792
    s_mov_b32 s51, 0x20000
    s_mov_b32 s52, s18
    s_and_b32 s53, s19, 0xffff
    s_mov_b32 s54, 256
    s_mov_b32 s55, 0x20000
    v_lshrrev_b32 v2, 4, v1
    v_lshlrev_b32 v2, 3, v2
    v_bfe_u32 v3, v1, 2, 2
    v_and_b32 v4, 3, v1
    v_lshlrev_b32 v5, 2, v3
    v_lshrrev_b32 v6, 1, v4
    v_add_u32 v6, 2, v6
    v_and_b32 v7, v4, v6
    v_cmp_eq_u32 vcc, 3, v4
    v_lshlrev_b32 v7, 1, v4
    s_nop 0
    v_addc_co_u32 v7, vcc, 0, v7, vcc
    s_mul_i32 s72, s60, 11544
    s_mul_i32 s73, s60, 6816
    s_add_u32 s73, s73, 92352
    s_add_u32 s74, s73, 560
    v_mov_b32 v130, s74
    s_mov_b32 s70, 219488800
    v_bfe_u32 v8, s70, v2, 8
    v_lshrrev_b32 v9, 2, v8
    v_and_b32 v8, 3, v8
    v_add_u32 v131, v9, v5
    v_min_u32 v131, 19, v131
    v_add_u32 v132, v8, v4
    v_min_u32 v132, 4, v132
    v_mul_u32_u24 v131, 48, v131
    v_lshl_add_u32 v131, v132, 3, v131
    v_add_u32 v114, s72, v131
    v_sub_u32 v9, v9, v3
    v_cmp_gt_u32 vcc, 7, v9
    v_cmp_lt_u32 s[76:77], v8, v6
    s_and_b64 vcc, vcc, s[76:77]
    v_add_u32 v8, v8, v7
    v_mul_u32_u24 v9, 80, v9
    v_lshl_add_u32 v9, v8, 3, v9
    v_add_u32 v9, s73, v9
    v_cndmask_b32 v122, v130, v9, vcc
    s_mov_b32 s70, 168565790
    v_bfe_u32 v8, s70, v2, 8
    v_lshrrev_b32 v9, 2, v8
    v_and_b32 v8, 3, v8
    v_add_u32 v131, v9, v5
    v_min_u32 v131, 19, v131
    v_add_u32 v132, v8, v4
    v_min_u32 v132, 4, v132
    v_mul_u32_u24 v131, 48, v131
    v_lshl_add_u32 v131, v132, 3, v131
    v_add_u32 v115, s72, v131
    v_sub_u32 v9, v9, v3
    v_cmp_gt_u32 vcc, 7, v9
    v_cmp_lt_u32 s[76:77], v8, v6
    s_and_b64 vcc, vcc, s[76:77]
    v_add_u32 v8, v8, v7
    v_mul_u32_u24 v9, 80, v9
    v_lshl_add_u32 v9, v8, 3, v9
    v_add_u32 v9, s73, v9
    v_cndmask_b32 v123, v130, v9, vcc
    s_mov_b32 s70, 437402624
    v_bfe_u32 v8, s70, v2, 8
    v_lshrrev_b32 v9, 2, v8
    v_and_b32 v8, 3, v8
    v_add_u32 v131, v9, v5
    v_min_u32 v131, 19, v131
    v_add_u32 v132, v8, v4
    v_min_u32 v132, 4, v132
    v_mul_u32_u24 v131, 48, v131
    v_lshl_add_u32 v131, v132, 3, v131
    v_add_u32 v116, s72, v131
    v_sub_u32 v9, v9, v3
    v_cmp_gt_u32 vcc, 7, v9
    v_cmp_lt_u32 s[76:77], v8, v6
    s_and_b64 vcc, vcc, s[76:77]
    v_add_u32 v8, v8, v7
    v_mul_u32_u24 v9, 80, v9
    v_lshl_add_u32 v9, v8, 3, v9
    v_add_u32 v9, s73, v9
    v_cndmask_b32 v124, v130, v9, vcc
    s_mov_b32 s70, 420550662
    v_bfe_u32 v8, s70, v2, 8
    v_lshrrev_b32 v9, 2, v8
    v_and_b32 v8, 3, v8
    v_add_u32 v131, v9, v5
    v_min_u32 v131, 19, v131
    v_add_u32 v132, v8, v4
    v_min_u32 v132, 4, v132
    v_mul_u32_u24 v131, 48, v131
    v_lshl_add_u32 v131, v132, 3, v131
    v_add_u32 v117, s72, v131
    v_sub_u32 v9, v9, v3
    v_cmp_gt_u32 vcc, 7, v9
    v_cmp_lt_u32 s[76:77], v8, v6
    s_and_b64 vcc, vcc, s[76:77]
    v_add_u32 v8, v8, v7
    v_mul_u32_u24 v9, 80, v9
    v_lshl_add_u32 v9, v8, 3, v9
    v_add_u32 v9, s73, v9
    v_cndmask_b32 v125, v130, v9, vcc
    s_mov_b32 s70, 67441666
    v_bfe_u32 v8, s70, v2, 8
    v_lshrrev_b32 v9, 2, v8
    v_and_b32 v8, 3, v8
    v_add_u32 v131, v9, v5
    v_min_u32 v131, 19, v131
    v_add_u32 v132, v8, v4
    v_min_u32 v132, 4, v132
    v_mul_u32_u24 v131, 48, v131
    v_lshl_add_u32 v131, v132, 3, v131
    v_add_u32 v118, s72, v131
    v_sub_u32 v9, v9, v3
    v_cmp_gt_u32 vcc, 7, v9
    v_cmp_lt_u32 s[76:77], v8, v6
    s_and_b64 vcc, vcc, s[76:77]
    v_add_u32 v8, v8, v7
    v_mul_u32_u24 v9, 80, v9
    v_lshl_add_u32 v9, v8, 3, v9
    v_add_u32 v9, s73, v9
    v_cndmask_b32 v126, v130, v9, vcc
    s_mov_b32 s70, 235929865
    v_bfe_u32 v8, s70, v2, 8
    v_lshrrev_b32 v9, 2, v8
    v_and_b32 v8, 3, v8
    v_add_u32 v131, v9, v5
    v_min_u32 v131, 19, v131
    v_add_u32 v132, v8, v4
    v_min_u32 v132, 4, v132
    v_mul_u32_u24 v131, 48, v131
    v_lshl_add_u32 v131, v132, 3, v131
    v_add_u32 v119, s72, v131
    v_sub_u32 v9, v9, v3
    v_cmp_gt_u32 vcc, 7, v9
    v_cmp_lt_u32 s[76:77], v8, v6
    s_and_b64 vcc, vcc, s[76:77]
    v_add_u32 v8, v8, v7
    v_mul_u32_u24 v9, 80, v9
    v_lshl_add_u32 v9, v8, 3, v9
    v_add_u32 v9, s73, v9
    v_cndmask_b32 v127, v130, v9, vcc
    s_mov_b32 s70, 488973345
    v_bfe_u32 v8, s70, v2, 8
    v_lshrrev_b32 v9, 2, v8
    v_and_b32 v8, 3, v8
    v_add_u32 v131, v9, v5
    v_min_u32 v131, 19, v131
    v_add_u32 v132, v8, v4
    v_min_u32 v132, 4, v132
    v_mul_u32_u24 v131, 48, v131
    v_lshl_add_u32 v131, v132, 3, v131
    v_add_u32 v120, s72, v131
    v_sub_u32 v9, v9, v3
    v_cmp_gt_u32 vcc, 7, v9
    v_cmp_lt_u32 s[76:77], v8, v6
    s_and_b64 vcc, vcc, s[76:77]
    v_add_u32 v8, v8, v7
    v_mul_u32_u24 v9, 80, v9
    v_lshl_add_u32 v9, v8, 3, v9
    v_add_u32 v9, s73, v9
    v_cndmask_b32 v128, v130, v9, vcc
    s_mov_b32 s70, 638991368
    v_bfe_u32 v8, s70, v2, 8
    v_lshrrev_b32 v9, 2, v8
    v_and_b32 v8, 3, v8
    v_add_u32 v131, v9, v5
    v_min_u32 v131, 19, v131
    v_add_u32 v132, v8, v4
    v_min_u32 v132, 4, v132
    v_mul_u32_u24 v131, 48, v131
    v_lshl_add_u32 v131, v132, 3, v131
    v_add_u32 v121, s72, v131
    v_sub_u32 v9, v9, v3
    v_cmp_gt_u32 vcc, 7, v9
    v_cmp_lt_u32 s[76:77], v8, v6
    s_and_b64 vcc, vcc, s[76:77]
    v_add_u32 v8, v8, v7
    v_mul_u32_u24 v9, 80, v9
    v_lshl_add_u32 v9, v8, 3, v9
    v_add_u32 v9, s73, v9
    v_cndmask_b32 v129, v130, v9, vcc
    s_cmp_lg_u32 s63, 0
    s_cbranch_scc1 L_after
    s_mov_b32 s78, 0x05040100
    s_mov_b32 s79, 0x07060302
    s_waitcnt vmcnt(12)
    v_mov_b32 v140, 0
    v_mov_b32 v145, 0
    v_mov_b32 v146, 0
    v_mov_b32 v151, 0
    v_mov_b32 v152, 0
    v_mov_b32 v153, 0
    v_cmp_gt_u32 vcc, 48, v0
    s_and_saveexec_b64 s[76:77], vcc
    s_cbranch_execz L_zs
    ds_write_b64 v15, v[152:153] offset:560
    ds_write_b64 v15, v[152:153] offset:1128
L_zs:
    s_mov_b64 exec, s[76:77]
    v_perm_b32 v141, v101, v100, s78
    v_perm_b32 v142, v103, v102, s78
    v_perm_b32 v143, v105, v104, s78
    v_and_b32 v144, 0xffff, v106
    v_lshlrev_b32 v147, 16, v100
    v_perm_b32 v148, v102, v101, s78
    v_perm_b32 v149, v104, v103, s78
    v_perm_b32 v150, v106, v105, s78
    ds_write2_b32 v15, v141, v142 offset0:0 offset1:1
    ds_write2_b32 v15, v143, v144 offset0:2 offset1:3
    ds_write2_b32 v15, v147, v148 offset0:4 offset1:5
    ds_write2_b32 v15, v149, v150 offset0:6 offset1:7
    ds_write2_b64 v15, v[140:141], v[142:143] offset0:4 offset1:5
    ds_write2_b64 v15, v[144:145], v[146:147] offset0:6 offset1:7
    ds_write2_b64 v15, v[148:149], v[150:151] offset0:8 offset1:9
    v_perm_b32 v141, v101, v100, s79
    v_perm_b32 v142, v103, v102, s79
    v_perm_b32 v143, v105, v104, s79
    v_lshrrev_b32 v144, 16, v106
    v_and_b32 v147, s66, v100
    v_perm_b32 v148, v102, v101, s79
    v_perm_b32 v149, v104, v103, s79
    v_perm_b32 v150, v106, v105, s79
    ds_write2_b32 v15, v141, v142 offset0:142 offset1:143
    ds_write2_b32 v15, v143, v144 offset0:144 offset1:145
    ds_write2_b32 v15, v147, v148 offset0:146 offset1:147
    ds_write2_b32 v15, v149, v150 offset0:148 offset1:149
    ds_write2_b64 v15, v[140:141], v[142:143] offset0:75 offset1:76
    ds_write2_b64 v15, v[144:145], v[146:147] offset0:77 offset1:78
    ds_write2_b64 v15, v[148:149], v[150:151] offset0:79 offset1:80
    v_cmp_gt_u32 vcc, 80, v0
    s_and_saveexec_b64 s[76:77], vcc
    s_cbranch_execz L_tb
    v_perm_b32 v141, v108, v107, s78
    v_perm_b32 v142, v110, v109, s78
    v_perm_b32 v143, v112, v111, s78
    v_and_b32 v144, 0xffff, v113
    v_lshlrev_b32 v147, 16, v107
    v_perm_b32 v148, v109, v108, s78
    v_perm_b32 v149, v111, v110, s78
    v_perm_b32 v150, v113, v112, s78
    ds_write2_b32 v133, v141, v142 offset0:0 offset1:1
    ds_write2_b32 v133, v143, v144 offset0:2 offset1:3
    ds_write2_b32 v133, v147, v148 offset0:4 offset1:5
    ds_write2_b32 v133, v149, v150 offset0:6 offset1:7
    ds_write2_b64 v133, v[140:141], v[142:143] offset0:4 offset1:5
    ds_write2_b64 v133, v[144:145], v[146:147] offset0:6 offset1:7
    ds_write2_b64 v133, v[148:149], v[150:151] offset0:8 offset1:9
    v_perm_b32 v141, v108, v107, s79
    v_perm_b32 v142, v110, v109, s79
    v_perm_b32 v143, v112, v111, s79
    v_lshrrev_b32 v144, 16, v113
    v_and_b32 v147, s66, v107
    v_perm_b32 v148, v109, v108, s79
    v_perm_b32 v149, v111, v110, s79
    v_perm_b32 v150, v113, v112, s79
    ds_write2_b32 v133, v141, v142 offset0:142 offset1:143
    ds_write2_b32 v133, v143, v144 offset0:144 offset1:145
    ds_write2_b32 v133, v147, v148 offset0:146 offset1:147
    ds_write2_b32 v133, v149, v150 offset0:148 offset1:149
    ds_write2_b64 v133, v[140:141], v[142:143] offset0:75 offset1:76
    ds_write2_b64 v133, v[144:145], v[146:147] offset0:77 offset1:78
    ds_write2_b64 v133, v[148:149], v[150:151] offset0:79 offset1:80
L_tb:
    s_mov_b64 exec, s[76:77]
L_after:
    s_mov_b32 s78, 0x05040100
    s_mov_b32 s79, 0x07060302
    s_waitcnt vmcnt(8)
    v_perm_b32 v136, v20, v16, s78
    v_perm_b32 v137, v28, v24, s78
    v_perm_b32 v138, v20, v16, s79
    v_perm_b32 v139, v28, v24, s79
    ds_write_b64 v10, v[136:137] offset:0
    ds_write_b64 v10, v[138:139] offset:960
    v_perm_b32 v140, v21, v17, s78
    v_perm_b32 v141, v29, v25, s78
    v_perm_b32 v142, v21, v17, s79
    v_perm_b32 v143, v29, v25, s79
    ds_write_b64 v10, v[140:141] offset:1920
    ds_write_b64 v10, v[142:143] offset:2880
    v_perm_b32 v136, v22, v18, s78
    v_perm_b32 v137, v30, v26, s78
    v_perm_b32 v138, v22, v18, s79
    v_perm_b32 v139, v30, v26, s79
    ds_write_b64 v10, v[136:137] offset:3848
    ds_write_b64 v10, v[138:139] offset:4808
    v_perm_b32 v140, v23, v19, s78
    v_perm_b32 v141, v31, v27, s78
    v_perm_b32 v142, v23, v19, s79
    v_perm_b32 v143, v31, v27, s79
    ds_write_b64 v10, v[140:141] offset:5768
    ds_write_b64 v10, v[142:143] offset:6728
    s_waitcnt vmcnt(4)
    v_perm_b32 v136, v36, v32, s78
    v_perm_b32 v137, v44, v40, s78
    v_perm_b32 v138, v36, v32, s79
    v_perm_b32 v139, v44, v40, s79
    ds_write_b64 v11, v[136:137] offset:0
    ds_write_b64 v11, v[138:139] offset:960
    v_perm_b32 v140, v37, v33, s78
    v_perm_b32 v141, v45, v41, s78
    v_perm_b32 v142, v37, v33, s79
    v_perm_b32 v143, v45, v41, s79
    ds_write_b64 v11, v[140:141] offset:1920
    ds_write_b64 v11, v[142:143] offset:2880
    v_perm_b32 v136, v38, v34, s78
    v_perm_b32 v137, v46, v42, s78
    v_perm_b32 v138, v38, v34, s79
    v_perm_b32 v139, v46, v42, s79
    ds_write_b64 v11, v[136:137] offset:3848
    ds_write_b64 v11, v[138:139] offset:4808
    v_perm_b32 v140, v39, v35, s78
    v_perm_b32 v141, v47, v43, s78
    v_perm_b32 v142, v39, v35, s79
    v_perm_b32 v143, v47, v43, s79
    ds_write_b64 v11, v[140:141] offset:5768
    ds_write_b64 v11, v[142:143] offset:6728
    s_waitcnt vmcnt(0)
    v_cmp_gt_u32 vcc, 1200-1024, v0
    s_and_saveexec_b64 s[76:77], vcc
    s_cbranch_execz L_x2skip
    v_perm_b32 v136, v52, v48, s78
    v_perm_b32 v137, v60, v56, s78
    v_perm_b32 v138, v52, v48, s79
    v_perm_b32 v139, v60, v56, s79
    ds_write_b64 v12, v[136:137] offset:0
    ds_write_b64 v12, v[138:139] offset:960
    v_perm_b32 v140, v53, v49, s78
    v_perm_b32 v141, v61, v57, s78
    v_perm_b32 v142, v53, v49, s79
    v_perm_b32 v143, v61, v57, s79
    ds_write_b64 v12, v[140:141] offset:1920
    ds_write_b64 v12, v[142:143] offset:2880
    v_perm_b32 v136, v54, v50, s78
    v_perm_b32 v137, v62, v58, s78
    v_perm_b32 v138, v54, v50, s79
    v_perm_b32 v139, v62, v58, s79
    ds_write_b64 v12, v[136:137] offset:3848
    ds_write_b64 v12, v[138:139] offset:4808
    v_perm_b32 v140, v55, v51, s78
    v_perm_b32 v141, v63, v59, s78
    v_perm_b32 v142, v55, v51, s79
    v_perm_b32 v143, v63, v59, s79
    ds_write_b64 v12, v[140:141] offset:5768
    ds_write_b64 v12, v[142:143] offset:6728
L_x2skip:
    s_mov_b64 exec, s[76:77]
    s_waitcnt lgkmcnt(0)
    s_barrier
    s_cmp_ge_u32 s2, 96
    s_cbranch_scc1 L_nordy
    s_cmp_lg_u32 s60, 0
    s_cbranch_scc1 L_nordy
    v_mov_b32 v2, 1
    v_mov_b32 v3, 0
    s_mov_b64 exec, 1
    buffer_atomic_add v2, v3, s[52:55], 0 offen sc1
    s_mov_b64 exec, -1
L_nordy:
    v_lshrrev_b32 v2, 4, v0
    v_and_b32 v3, 15, v0
    v_mul_u32_u24 v4, 768, v2
    v_lshl_add_u32 v4, v3, 4, v4
    v_mul_u32_u24 v14, 832, v2
    v_lshl_add_u32 v14, v3, 4, v14
    v_add_u32 v14, 46592, v14
    s_mov_b32 s70, 24576
    s_mov_b32 s71, 49152
    ds_read_b64 v[188:189], v114 offset:0
    ds_read_b64 v[190:191], v115 offset:0
    ds_read_b64 v[192:193], v122 offset:0
    ds_read_b64 v[194:195], v123 offset:0
    ds_read_b64 v[196:197], v116 offset:0
    ds_read_b64 v[198:199], v117 offset:0
    ds_read_b64 v[200:201], v124 offset:0
    ds_read_b64 v[202:203], v125 offset:0
    ds_read_b64 v[204:205], v118 offset:0
    ds_read_b64 v[206:207], v119 offset:0
    ds_read_b64 v[208:209], v126 offset:0
    ds_read_b64 v[210:211], v127 offset:0
    buffer_load_dwordx4 v[64:67], v4, s[32:35], 0 offen offset:0
    buffer_load_dwordx4 v[68:71], v4, s[32:35], 0 offen offset:256
    buffer_load_dwordx4 v[72:75], v4, s[32:35], 0 offen offset:512
    buffer_load_dwordx4 v[76:79], v4, s[32:35], s70 offen offset:0
    buffer_load_dwordx4 v[80:83], v4, s[32:35], s70 offen offset:256
    buffer_load_dwordx4 v[84:87], v4, s[32:35], s70 offen offset:512
    buffer_load_dwordx4 v[88:91], v4, s[32:35], s71 offen offset:0
    buffer_load_dwordx4 v[92:95], v4, s[32:35], s71 offen offset:256
    buffer_load_dwordx4 v[96:99], v4, s[32:35], s71 offen offset:512
    ds_read_b64 v[212:213], v120 offset:0
    ds_read_b64 v[214:215], v121 offset:0
    ds_read_b64 v[216:217], v128 offset:0
    ds_read_b64 v[218:219], v129 offset:0
    s_waitcnt lgkmcnt(12)
    v_mfma_f32_16x16x32_bf16 v[140:143], v[188:191], v[192:195], 0
    ds_read_b64 v[220:221], v114 offset:960
    ds_read_b64 v[222:223], v115 offset:960
    ds_read_b64 v[224:225], v122 offset:568
    ds_read_b64 v[226:227], v123 offset:568
    s_waitcnt lgkmcnt(12)
    v_mfma_f32_16x16x32_bf16 v[140:143], v[196:199], v[200:203], v[140:143]
    ds_read_b64 v[228:229], v116 offset:960
    ds_read_b64 v[230:231], v117 offset:960
    ds_read_b64 v[232:233], v124 offset:568
    ds_read_b64 v[234:235], v125 offset:568
    s_waitcnt lgkmcnt(12)
    v_mfma_f32_16x16x32_bf16 v[140:143], v[204:207], v[208:211], v[140:143]
    ds_read_b64 v[188:189], v118 offset:960
    ds_read_b64 v[190:191], v119 offset:960
    ds_read_b64 v[192:193], v126 offset:568
    ds_read_b64 v[194:195], v127 offset:568
    s_waitcnt lgkmcnt(12)
    v_mfma_f32_16x16x32_bf16 v[140:143], v[212:215], v[216:219], v[140:143]
    ds_read_b64 v[196:197], v120 offset:960
    ds_read_b64 v[198:199], v121 offset:960
    ds_read_b64 v[200:201], v128 offset:568
    ds_read_b64 v[202:203], v129 offset:568
    s_waitcnt lgkmcnt(12)
    v_mfma_f32_16x16x32_bf16 v[144:147], v[220:223], v[224:227], 0
    ds_read_b64 v[204:205], v114 offset:1920
    ds_read_b64 v[206:207], v115 offset:1920
    ds_read_b64 v[208:209], v122 offset:1136
    ds_read_b64 v[210:211], v123 offset:1136
    s_waitcnt lgkmcnt(12)
    v_mfma_f32_16x16x32_bf16 v[144:147], v[228:231], v[232:235], v[144:147]
    ds_read_b64 v[212:213], v116 offset:1920
    ds_read_b64 v[214:215], v117 offset:1920
    ds_read_b64 v[216:217], v124 offset:1136
    ds_read_b64 v[218:219], v125 offset:1136
    s_waitcnt lgkmcnt(12)
    v_mfma_f32_16x16x32_bf16 v[144:147], v[188:191], v[192:195], v[144:147]
    ds_read_b64 v[220:221], v118 offset:1920
    ds_read_b64 v[222:223], v119 offset:1920
    ds_read_b64 v[224:225], v126 offset:1136
    ds_read_b64 v[226:227], v127 offset:1136
    s_waitcnt lgkmcnt(12)
    v_mfma_f32_16x16x32_bf16 v[144:147], v[196:199], v[200:203], v[144:147]
    ds_read_b64 v[228:229], v120 offset:1920
    ds_read_b64 v[230:231], v121 offset:1920
    ds_read_b64 v[232:233], v128 offset:1136
    ds_read_b64 v[234:235], v129 offset:1136
    s_waitcnt lgkmcnt(12)
    v_mfma_f32_16x16x32_bf16 v[148:151], v[204:207], v[208:211], 0
    ds_read_b64 v[188:189], v114 offset:2880
    ds_read_b64 v[190:191], v115 offset:2880
    ds_read_b64 v[192:193], v122 offset:1704
    ds_read_b64 v[194:195], v123 offset:1704
    s_waitcnt lgkmcnt(12)
    v_mfma_f32_16x16x32_bf16 v[148:151], v[212:215], v[216:219], v[148:151]
    ds_read_b64 v[196:197], v116 offset:2880
    ds_read_b64 v[198:199], v117 offset:2880
    ds_read_b64 v[200:201], v124 offset:1704
    ds_read_b64 v[202:203], v125 offset:1704
    s_waitcnt lgkmcnt(12)
    v_mfma_f32_16x16x32_bf16 v[148:151], v[220:223], v[224:227], v[148:151]
    ds_read_b64 v[204:205], v118 offset:2880
    ds_read_b64 v[206:207], v119 offset:2880
    ds_read_b64 v[208:209], v126 offset:1704
    ds_read_b64 v[210:211], v127 offset:1704
    s_waitcnt lgkmcnt(12)
    v_mfma_f32_16x16x32_bf16 v[148:151], v[228:231], v[232:235], v[148:151]
    ds_read_b64 v[212:213], v120 offset:2880
    ds_read_b64 v[214:215], v121 offset:2880
    ds_read_b64 v[216:217], v128 offset:1704
    ds_read_b64 v[218:219], v129 offset:1704
    s_waitcnt lgkmcnt(12)
    v_mfma_f32_16x16x32_bf16 v[152:155], v[188:191], v[192:195], 0
    ds_read_b64 v[220:221], v114 offset:3848
    ds_read_b64 v[222:223], v115 offset:3848
    ds_read_b64 v[224:225], v122 offset:2272
    ds_read_b64 v[226:227], v123 offset:2272
    s_waitcnt lgkmcnt(12)
    v_mfma_f32_16x16x32_bf16 v[152:155], v[196:199], v[200:203], v[152:155]
    ds_read_b64 v[228:229], v116 offset:3848
    ds_read_b64 v[230:231], v117 offset:3848
    ds_read_b64 v[232:233], v124 offset:2272
    ds_read_b64 v[234:235], v125 offset:2272
    s_waitcnt lgkmcnt(12)
    v_mfma_f32_16x16x32_bf16 v[152:155], v[204:207], v[208:211], v[152:155]
    ds_read_b64 v[188:189], v118 offset:3848
    ds_read_b64 v[190:191], v119 offset:3848
    ds_read_b64 v[192:193], v126 offset:2272
    ds_read_b64 v[194:195], v127 offset:2272
    s_waitcnt lgkmcnt(12)
    v_mfma_f32_16x16x32_bf16 v[152:155], v[212:215], v[216:219], v[152:155]
    ds_read_b64 v[196:197], v120 offset:3848
    ds_read_b64 v[198:199], v121 offset:3848
    ds_read_b64 v[200:201], v128 offset:2272
    ds_read_b64 v[202:203], v129 offset:2272
    s_waitcnt lgkmcnt(12)
    v_mfma_f32_16x16x32_bf16 v[156:159], v[220:223], v[224:227], 0
    ds_read_b64 v[204:205], v114 offset:4808
    ds_read_b64 v[206:207], v115 offset:4808
    ds_read_b64 v[208:209], v122 offset:2840
    ds_read_b64 v[210:211], v123 offset:2840
    s_waitcnt lgkmcnt(12)
    v_mfma_f32_16x16x32_bf16 v[156:159], v[228:231], v[232:235], v[156:159]
    ds_read_b64 v[212:213], v116 offset:4808
    ds_read_b64 v[214:215], v117 offset:4808
    ds_read_b64 v[216:217], v124 offset:2840
    ds_read_b64 v[218:219], v125 offset:2840
    s_waitcnt lgkmcnt(12)
    v_mfma_f32_16x16x32_bf16 v[156:159], v[188:191], v[192:195], v[156:159]
    ds_read_b64 v[220:221], v118 offset:4808
    ds_read_b64 v[222:223], v119 offset:4808
    ds_read_b64 v[224:225], v126 offset:2840
    ds_read_b64 v[226:227], v127 offset:2840
    s_waitcnt lgkmcnt(12)
    v_mfma_f32_16x16x32_bf16 v[156:159], v[196:199], v[200:203], v[156:159]
    ds_read_b64 v[228:229], v120 offset:4808
    ds_read_b64 v[230:231], v121 offset:4808
    ds_read_b64 v[232:233], v128 offset:2840
    ds_read_b64 v[234:235], v129 offset:2840
    s_waitcnt lgkmcnt(12)
    v_mfma_f32_16x16x32_bf16 v[160:163], v[204:207], v[208:211], 0
    ds_read_b64 v[188:189], v114 offset:5768
    ds_read_b64 v[190:191], v115 offset:5768
    ds_read_b64 v[192:193], v122 offset:3408
    ds_read_b64 v[194:195], v123 offset:3408
    s_waitcnt lgkmcnt(12)
    v_mfma_f32_16x16x32_bf16 v[160:163], v[212:215], v[216:219], v[160:163]
    ds_read_b64 v[196:197], v116 offset:5768
    ds_read_b64 v[198:199], v117 offset:5768
    ds_read_b64 v[200:201], v124 offset:3408
    ds_read_b64 v[202:203], v125 offset:3408
    s_waitcnt lgkmcnt(12)
    v_mfma_f32_16x16x32_bf16 v[160:163], v[220:223], v[224:227], v[160:163]
    ds_read_b64 v[204:205], v118 offset:5768
    ds_read_b64 v[206:207], v119 offset:5768
    ds_read_b64 v[208:209], v126 offset:3408
    ds_read_b64 v[210:211], v127 offset:3408
    s_waitcnt lgkmcnt(12)
    v_mfma_f32_16x16x32_bf16 v[160:163], v[228:231], v[232:235], v[160:163]
    ds_read_b64 v[212:213], v120 offset:5768
    ds_read_b64 v[214:215], v121 offset:5768
    ds_read_b64 v[216:217], v128 offset:3408
    ds_read_b64 v[218:219], v129 offset:3408
    s_waitcnt lgkmcnt(12)
    v_mfma_f32_16x16x32_bf16 v[164:167], v[188:191], v[192:195], 0
    ds_read_b64 v[220:221], v114 offset:6728
    ds_read_b64 v[222:223], v115 offset:6728
    ds_read_b64 v[224:225], v122 offset:3976
    ds_read_b64 v[226:227], v123 offset:3976
    s_waitcnt lgkmcnt(12)
    v_mfma_f32_16x16x32_bf16 v[164:167], v[196:199], v[200:203], v[164:167]
    ds_read_b64 v[228:229], v116 offset:6728
    ds_read_b64 v[230:231], v117 offset:6728
    ds_read_b64 v[232:233], v124 offset:3976
    ds_read_b64 v[234:235], v125 offset:3976
    s_waitcnt lgkmcnt(12)
    v_mfma_f32_16x16x32_bf16 v[164:167], v[204:207], v[208:211], v[164:167]
    ds_read_b64 v[188:189], v118 offset:6728
    ds_read_b64 v[190:191], v119 offset:6728
    ds_read_b64 v[192:193], v126 offset:3976
    ds_read_b64 v[194:195], v127 offset:3976
    s_waitcnt lgkmcnt(12)
    v_mfma_f32_16x16x32_bf16 v[164:167], v[212:215], v[216:219], v[164:167]
    ds_read_b64 v[196:197], v120 offset:6728
    ds_read_b64 v[198:199], v121 offset:6728
    ds_read_b64 v[200:201], v128 offset:3976
    ds_read_b64 v[202:203], v129 offset:3976
    s_waitcnt lgkmcnt(12)
    v_mfma_f32_16x16x32_bf16 v[168:171], v[220:223], v[224:227], 0
    ds_read_b64 v[204:205], v114 offset:7696
    ds_read_b64 v[206:207], v115 offset:7696
    ds_read_b64 v[208:209], v122 offset:4544
    ds_read_b64 v[210:211], v123 offset:4544
    s_waitcnt lgkmcnt(12)
    v_mfma_f32_16x16x32_bf16 v[168:171], v[228:231], v[232:235], v[168:171]
    ds_read_b64 v[212:213], v116 offset:7696
    ds_read_b64 v[214:215], v117 offset:7696
    ds_read_b64 v[216:217], v124 offset:4544
    ds_read_b64 v[218:219], v125 offset:4544
    s_waitcnt lgkmcnt(12)
    v_mfma_f32_16x16x32_bf16 v[168:171], v[188:191], v[192:195], v[168:171]
    ds_read_b64 v[220:221], v118 offset:7696
    ds_read_b64 v[222:223], v119 offset:7696
    ds_read_b64 v[224:225], v126 offset:4544
    ds_read_b64 v[226:227], v127 offset:4544
    s_waitcnt lgkmcnt(12)
    v_mfma_f32_16x16x32_bf16 v[168:171], v[196:199], v[200:203], v[168:171]
    ds_read_b64 v[228:229], v120 offset:7696
    ds_read_b64 v[230:231], v121 offset:7696
    ds_read_b64 v[232:233], v128 offset:4544
    ds_read_b64 v[234:235], v129 offset:4544
    s_waitcnt lgkmcnt(12)
    v_mfma_f32_16x16x32_bf16 v[172:175], v[204:207], v[208:211], 0
    ds_read_b64 v[188:189], v114 offset:8656
    ds_read_b64 v[190:191], v115 offset:8656
    ds_read_b64 v[192:193], v122 offset:5112
    ds_read_b64 v[194:195], v123 offset:5112
    s_waitcnt lgkmcnt(12)
    v_mfma_f32_16x16x32_bf16 v[172:175], v[212:215], v[216:219], v[172:175]
    ds_read_b64 v[196:197], v116 offset:8656
    ds_read_b64 v[198:199], v117 offset:8656
    ds_read_b64 v[200:201], v124 offset:5112
    ds_read_b64 v[202:203], v125 offset:5112
    s_waitcnt lgkmcnt(12)
    v_mfma_f32_16x16x32_bf16 v[172:175], v[220:223], v[224:227], v[172:175]
    ds_read_b64 v[204:205], v118 offset:8656
    ds_read_b64 v[206:207], v119 offset:8656
    ds_read_b64 v[208:209], v126 offset:5112
    ds_read_b64 v[210:211], v127 offset:5112
    s_waitcnt lgkmcnt(12)
    v_mfma_f32_16x16x32_bf16 v[172:175], v[228:231], v[232:235], v[172:175]
    ds_read_b64 v[212:213], v120 offset:8656
    ds_read_b64 v[214:215], v121 offset:8656
    ds_read_b64 v[216:217], v128 offset:5112
    ds_read_b64 v[218:219], v129 offset:5112
    s_waitcnt lgkmcnt(12)
    v_mfma_f32_16x16x32_bf16 v[176:179], v[188:191], v[192:195], 0
    ds_read_b64 v[220:221], v114 offset:9616
    ds_read_b64 v[222:223], v115 offset:9616
    ds_read_b64 v[224:225], v122 offset:5680
    ds_read_b64 v[226:227], v123 offset:5680
    s_waitcnt lgkmcnt(12)
    v_mfma_f32_16x16x32_bf16 v[176:179], v[196:199], v[200:203], v[176:179]
    ds_read_b64 v[228:229], v116 offset:9616
    ds_read_b64 v[230:231], v117 offset:9616
    ds_read_b64 v[232:233], v124 offset:5680
    ds_read_b64 v[234:235], v125 offset:5680
    s_waitcnt lgkmcnt(12)
    v_mfma_f32_16x16x32_bf16 v[176:179], v[204:207], v[208:211], v[176:179]
    ds_read_b64 v[188:189], v118 offset:9616
    ds_read_b64 v[190:191], v119 offset:9616
    ds_read_b64 v[192:193], v126 offset:5680
    ds_read_b64 v[194:195], v127 offset:5680
    s_waitcnt lgkmcnt(12)
    v_mfma_f32_16x16x32_bf16 v[176:179], v[212:215], v[216:219], v[176:179]
    ds_read_b64 v[196:197], v120 offset:9616
    ds_read_b64 v[198:199], v121 offset:9616
    ds_read_b64 v[200:201], v128 offset:5680
    ds_read_b64 v[202:203], v129 offset:5680
    s_waitcnt lgkmcnt(12)
    v_mfma_f32_16x16x32_bf16 v[180:183], v[220:223], v[224:227], 0
    ds_read_b64 v[204:205], v114 offset:10576
    ds_read_b64 v[206:207], v115 offset:10576
    ds_read_b64 v[208:209], v122 offset:6248
    ds_read_b64 v[210:211], v123 offset:6248
    s_waitcnt lgkmcnt(12)
    v_mfma_f32_16x16x32_bf16 v[180:183], v[228:231], v[232:235], v[180:183]
    ds_read_b64 v[212:213], v116 offset:10576
    ds_read_b64 v[214:215], v117 offset:10576
    ds_read_b64 v[216:217], v124 offset:6248
    ds_read_b64 v[218:219], v125 offset:6248
    s_waitcnt lgkmcnt(12)
    v_mfma_f32_16x16x32_bf16 v[180:183], v[188:191], v[192:195], v[180:183]
    ds_read_b64 v[220:221], v118 offset:10576
    ds_read_b64 v[222:223], v119 offset:10576
    ds_read_b64 v[224:225], v126 offset:6248
    ds_read_b64 v[226:227], v127 offset:6248
    s_waitcnt lgkmcnt(12)
    v_mfma_f32_16x16x32_bf16 v[180:183], v[196:199], v[200:203], v[180:183]
    ds_read_b64 v[228:229], v120 offset:10576
    ds_read_b64 v[230:231], v121 offset:10576
    ds_read_b64 v[232:233], v128 offset:6248
    ds_read_b64 v[234:235], v129 offset:6248
    s_waitcnt lgkmcnt(12)
    v_mfma_f32_16x16x32_bf16 v[184:187], v[204:207], v[208:211], 0
    s_waitcnt lgkmcnt(8)
    v_mfma_f32_16x16x32_bf16 v[184:187], v[212:215], v[216:219], v[184:187]
    s_waitcnt lgkmcnt(4)
    v_mfma_f32_16x16x32_bf16 v[184:187], v[220:223], v[224:227], v[184:187]
    s_waitcnt lgkmcnt(0)
    v_mfma_f32_16x16x32_bf16 v[184:187], v[228:231], v[232:235], v[184:187]
    v_lshrrev_b32 v6, 4, v1
    v_bfe_u32 v7, v1, 2, 2
    v_lshl_add_u32 v6, v6, 2, v7
    v_and_b32 v7, 3, v1
    v_mul_u32_u24 v8, 14, v6
    v_add_u32 v8, v8, v7
    v_mov_b32 v9, 200
    v_cmp_gt_u32 s[76:77], 14, v6
    s_mul_i32 s70, s60, 24
    v_add_u32 v2, 0, v8
    s_nop 1
    v_cndmask_b32 v2, v9, v2, s[76:77]
    v_mul_u32_u24 v2, 208, v2
    v_add_u32 v2, s70, v2
    v_add_u32 v3, 4, v8
    s_nop 1
    v_cndmask_b32 v3, v9, v3, s[76:77]
    v_mul_u32_u24 v3, 208, v3
    v_add_u32 v3, s70, v3
    v_add_u32 v4, 8, v8
    s_nop 1
    v_cndmask_b32 v4, v9, v4, s[76:77]
    v_mul_u32_u24 v4, 208, v4
    v_add_u32 v4, s70, v4
    v_add_u32 v5, 12, v8
    v_cmp_gt_u32 vcc, 2, v7
    s_and_b64 s[76:77], s[76:77], vcc
    s_nop 1
    v_cndmask_b32 v5, v9, v5, s[76:77]
    v_mul_u32_u24 v5, 208, v5
    v_add_u32 v5, s70, v5
    v_add_f32 v16, v140, v144
    v_mul_f32 v20, v140, v140
    v_add_f32 v17, v141, v145
    v_mul_f32 v21, v141, v141
    v_add_f32 v18, v142, v146
    v_mul_f32 v22, v142, v142
    v_add_f32 v19, v143, v147
    v_mul_f32 v23, v143, v143
    v_fma_f32 v20, v144, v144, v20
    v_fma_f32 v21, v145, v145, v21
    v_fma_f32 v22, v146, v146, v22
    v_fma_f32 v23, v147, v147, v23
    v_add_f32 v16, v16, v148
    v_fma_f32 v20, v148, v148, v20
    v_add_f32 v17, v17, v149
    v_fma_f32 v21, v149, v149, v21
    v_add_f32 v18, v18, v150
    v_fma_f32 v22, v150, v150, v22
    v_add_f32 v19, v19, v151
    v_fma_f32 v23, v151, v151, v23
    v_add_f32 v16, v16, v152
    v_fma_f32 v20, v152, v152, v20
    v_add_f32 v17, v17, v153
    v_fma_f32 v21, v153, v153, v21
    v_add_f32 v18, v18, v154
    v_fma_f32 v22, v154, v154, v22
    v_add_f32 v19, v19, v155
    v_fma_f32 v23, v155, v155, v23
    v_add_f32 v16, v16, v156
    v_fma_f32 v20, v156, v156, v20
    v_add_f32 v17, v17, v157
    v_fma_f32 v21, v157, v157, v21
    v_add_f32 v18, v18, v158
    v_fma_f32 v22, v158, v158, v22
    v_add_f32 v19, v19, v159
    v_fma_f32 v23, v159, v159, v23
    v_add_f32 v16, v16, v160
    v_fma_f32 v20, v160, v160, v20
    v_add_f32 v17, v17, v161
    v_fma_f32 v21, v161, v161, v21
    v_add_f32 v18, v18, v162
    v_fma_f32 v22, v162, v162, v22
    v_add_f32 v19, v19, v163
    v_fma_f32 v23, v163, v163, v23
    v_add_f32 v16, v16, v164
    v_fma_f32 v20, v164, v164, v20
    v_add_f32 v17, v17, v165
    v_fma_f32 v21, v165, v165, v21
    v_add_f32 v18, v18, v166
    v_fma_f32 v22, v166, v166, v22
    v_add_f32 v19, v19, v167
    v_fma_f32 v23, v167, v167, v23
    v_add_f32 v16, v16, v168
    v_fma_f32 v20, v168, v168, v20
    v_add_f32 v17, v17, v169
    v_fma_f32 v21, v169, v169, v21
    v_add_f32 v18, v18, v170
    v_fma_f32 v22, v170, v170, v22
    v_add_f32 v19, v19, v171
    v_fma_f32 v23, v171, v171, v23
    v_add_f32 v16, v16, v172
    v_fma_f32 v20, v172, v172, v20
    v_add_f32 v17, v17, v173
    v_fma_f32 v21, v173, v173, v21
    v_add_f32 v18, v18, v174
    v_fma_f32 v22, v174, v174, v22
    v_add_f32 v19, v19, v175
    v_fma_f32 v23, v175, v175, v23
    v_add_f32 v16, v16, v176
    v_fma_f32 v20, v176, v176, v20
    v_add_f32 v17, v17, v177
    v_fma_f32 v21, v177, v177, v21
    v_add_f32 v18, v18, v178
    v_fma_f32 v22, v178, v178, v22
    v_add_f32 v19, v19, v179
    v_fma_f32 v23, v179, v179, v23
    v_add_f32 v16, v16, v180
    v_fma_f32 v20, v180, v180, v20
    v_add_f32 v17, v17, v181
    v_fma_f32 v21, v181, v181, v21
    v_add_f32 v18, v18, v182
    v_fma_f32 v22, v182, v182, v22
    v_add_f32 v19, v19, v183
    v_fma_f32 v23, v183, v183, v23
    v_add_f32 v16, v16, v184
    v_fma_f32 v20, v184, v184, v20
    v_add_f32 v17, v17, v185
    v_fma_f32 v21, v185, v185, v21
    v_add_f32 v18, v18, v186
    v_fma_f32 v22, v186, v186, v22
    v_add_f32 v19, v19, v187
    v_fma_f32 v23, v187, v187, v23
    v_lshlrev_b32 v6, 4, v1
    v_add_u32 v6, 146880, v6
    s_lshl_b32 s70, s60, 11
    v_add_u32 v7, s70, v6
    ds_write_b128 v7, v[16:19]
    ds_write_b128 v7, v[20:23] offset:1024
    s_waitcnt lgkmcnt(0)
    s_barrier
    ds_read_b128 v[188:191], v6 offset:0
    ds_read_b128 v[192:195], v6 offset:1024
    ds_read_b128 v[196:199], v6 offset:2048
    ds_read_b128 v[200:203], v6 offset:3072
    ds_read_b128 v[204:207], v6 offset:4096
    ds_read_b128 v[208:211], v6 offset:5120
    ds_read_b128 v[212:215], v6 offset:6144
    ds_read_b128 v[216:219], v6 offset:7168
    ds_read_b128 v[220:223], v6 offset:8192
    ds_read_b128 v[224:227], v6 offset:9216
    ds_read_b128 v[228:231], v6 offset:10240
    ds_read_b128 v[232:235], v6 offset:11264
    ds_read_b128 v[24:27], v6 offset:12288
    ds_read_b128 v[28:31], v6 offset:13312
    ds_read_b128 v[32:35], v6 offset:14336
    ds_read_b128 v[36:39], v6 offset:15360
    s_cmp_eq_u32 s63, 0
    s_cbranch_scc1 L_w1a
    s_waitcnt vmcnt(0)
    ds_write_b128 v14, v[64:67] offset:0
    ds_write_b128 v14, v[68:71] offset:256
    ds_write_b128 v14, v[72:75] offset:512
    ds_write_b128 v14, v[76:79] offset:26624
    ds_write_b128 v14, v[80:83] offset:26880
    ds_write_b128 v14, v[84:87] offset:27136
    ds_write_b128 v14, v[88:91] offset:53248
    ds_write_b128 v14, v[92:95] offset:53504
    ds_write_b128 v14, v[96:99] offset:53760
    s_waitcnt lgkmcnt(9)
    s_branch L_w1b
L_w1a:
    s_waitcnt lgkmcnt(0)
L_w1b:
    v_pk_add_f32 v[188:189], v[188:189], v[196:197]
    v_pk_add_f32 v[190:191], v[190:191], v[198:199]
    v_pk_add_f32 v[192:193], v[192:193], v[200:201]
    v_pk_add_f32 v[194:195], v[194:195], v[202:203]
    v_pk_add_f32 v[204:205], v[204:205], v[212:213]
    v_pk_add_f32 v[206:207], v[206:207], v[214:215]
    v_pk_add_f32 v[208:209], v[208:209], v[216:217]
    v_pk_add_f32 v[210:211], v[210:211], v[218:219]
    v_pk_add_f32 v[220:221], v[220:221], v[228:229]
    v_pk_add_f32 v[222:223], v[222:223], v[230:231]
    v_pk_add_f32 v[224:225], v[224:225], v[232:233]
    v_pk_add_f32 v[226:227], v[226:227], v[234:235]
    v_pk_add_f32 v[24:25], v[24:25], v[32:33]
    v_pk_add_f32 v[26:27], v[26:27], v[34:35]
    v_pk_add_f32 v[28:29], v[28:29], v[36:37]
    v_pk_add_f32 v[30:31], v[30:31], v[38:39]
    v_pk_add_f32 v[188:189], v[188:189], v[204:205]
    v_pk_add_f32 v[190:191], v[190:191], v[206:207]
    v_pk_add_f32 v[192:193], v[192:193], v[208:209]
    v_pk_add_f32 v[194:195], v[194:195], v[210:211]
    v_pk_add_f32 v[220:221], v[220:221], v[24:25]
    v_pk_add_f32 v[222:223], v[222:223], v[26:27]
    v_pk_add_f32 v[224:225], v[224:225], v[28:29]
    v_pk_add_f32 v[226:227], v[226:227], v[30:31]
    v_pk_add_f32 v[188:189], v[188:189], v[220:221]
    v_pk_add_f32 v[190:191], v[190:191], v[222:223]
    v_pk_add_f32 v[192:193], v[192:193], v[224:225]
    v_pk_add_f32 v[194:195], v[194:195], v[226:227]
    s_mov_b32 s70, 1009429163
    s_mov_b32 s71, 925353388
    s_mov_b32 s72, 3203396952
    v_mul_f32 v188, s70, v188
    v_mul_f32 v189, s70, v189
    v_mul_f32 v190, s70, v190
    v_mul_f32 v191, s70, v191
    v_mul_f32 v196, v188, v188
    v_mul_f32 v197, v189, v189
    v_mul_f32 v198, v190, v190
    v_mul_f32 v199, v191, v191
    v_fma_f32 v192, v192, s70, -v196
    v_fma_f32 v193, v193, s70, -v197
    v_fma_f32 v194, v194, s70, -v198
    v_fma_f32 v195, v195, s70, -v199
    v_max_f32 v192, 0, v192
    v_add_f32 v192, s71, v192
    v_max_f32 v193, 0, v193
    v_add_f32 v193, s71, v193
    v_max_f32 v194, 0, v194
    v_add_f32 v194, s71, v194
    v_max_f32 v195, 0, v195
    v_add_f32 v195, s71, v195
    v_rsq_f32 v192, v192
    v_rsq_f32 v193, v193
    v_rsq_f32 v194, v194
    v_rsq_f32 v195, v195
    s_nop 0
    v_mul_f32 v192, s72, v192
    v_mul_f32 v193, s72, v193
    v_mul_f32 v194, s72, v194
    v_mul_f32 v195, s72, v195
    v_mul_f32 v188, v188, v192
    v_mul_f32 v189, v189, v193
    v_mul_f32 v190, v190, v194
    v_mul_f32 v191, v191, v195
    v_fma_f32 v140, v140, v192, -v188
    v_fma_f32 v144, v144, v192, -v188
    v_fma_f32 v148, v148, v192, -v188
    v_fma_f32 v152, v152, v192, -v188
    v_fma_f32 v156, v156, v192, -v188
    v_fma_f32 v160, v160, v192, -v188
    v_fma_f32 v164, v164, v192, -v188
    v_fma_f32 v168, v168, v192, -v188
    v_fma_f32 v172, v172, v192, -v188
    v_fma_f32 v176, v176, v192, -v188
    v_fma_f32 v180, v180, v192, -v188
    v_fma_f32 v184, v184, v192, -v188
    v_cvt_pk_bf16_f32 v200, v140, v144
    v_cvt_pk_bf16_f32 v201, v148, v152
    v_cvt_pk_bf16_f32 v202, v156, v160
    v_cvt_pk_bf16_f32 v203, v164, v168
    v_cvt_pk_bf16_f32 v204, v172, v176
    v_cvt_pk_bf16_f32 v205, v180, v184
    ds_write2_b64 v2, v[200:201], v[202:203] offset0:0 offset1:1
    ds_write_b64 v2, v[204:205] offset:16
    v_fma_f32 v141, v141, v193, -v189
    v_fma_f32 v145, v145, v193, -v189
    v_fma_f32 v149, v149, v193, -v189
    v_fma_f32 v153, v153, v193, -v189
    v_fma_f32 v157, v157, v193, -v189
    v_fma_f32 v161, v161, v193, -v189
    v_fma_f32 v165, v165, v193, -v189
    v_fma_f32 v169, v169, v193, -v189
    v_fma_f32 v173, v173, v193, -v189
    v_fma_f32 v177, v177, v193, -v189
    v_fma_f32 v181, v181, v193, -v189
    v_fma_f32 v185, v185, v193, -v189
    v_cvt_pk_bf16_f32 v206, v141, v145
    v_cvt_pk_bf16_f32 v207, v149, v153
    v_cvt_pk_bf16_f32 v208, v157, v161
    v_cvt_pk_bf16_f32 v209, v165, v169
    v_cvt_pk_bf16_f32 v210, v173, v177
    v_cvt_pk_bf16_f32 v211, v181, v185
    ds_write2_b64 v3, v[206:207], v[208:209] offset0:0 offset1:1
    ds_write_b64 v3, v[210:211] offset:16
    v_fma_f32 v142, v142, v194, -v190
    v_fma_f32 v146, v146, v194, -v190
    v_fma_f32 v150, v150, v194, -v190
    v_fma_f32 v154, v154, v194, -v190
    v_fma_f32 v158, v158, v194, -v190
    v_fma_f32 v162, v162, v194, -v190
    v_fma_f32 v166, v166, v194, -v190
    v_fma_f32 v170, v170, v194, -v190
    v_fma_f32 v174, v174, v194, -v190
    v_fma_f32 v178, v178, v194, -v190
    v_fma_f32 v182, v182, v194, -v190
    v_fma_f32 v186, v186, v194, -v190
    v_cvt_pk_bf16_f32 v200, v142, v146
    v_cvt_pk_bf16_f32 v201, v150, v154
    v_cvt_pk_bf16_f32 v202, v158, v162
    v_cvt_pk_bf16_f32 v203, v166, v170
    v_cvt_pk_bf16_f32 v204, v174, v178
    v_cvt_pk_bf16_f32 v205, v182, v186
    ds_write2_b64 v4, v[200:201], v[202:203] offset0:0 offset1:1
    ds_write_b64 v4, v[204:205] offset:16
    v_fma_f32 v143, v143, v195, -v191
    v_fma_f32 v147, v147, v195, -v191
    v_fma_f32 v151, v151, v195, -v191
    v_fma_f32 v155, v155, v195, -v191
    v_fma_f32 v159, v159, v195, -v191
    v_fma_f32 v163, v163, v195, -v191
    v_fma_f32 v167, v167, v195, -v191
    v_fma_f32 v171, v171, v195, -v191
    v_fma_f32 v175, v175, v195, -v191
    v_fma_f32 v179, v179, v195, -v191
    v_fma_f32 v183, v183, v195, -v191
    v_fma_f32 v187, v187, v195, -v191
    v_cvt_pk_bf16_f32 v206, v143, v147
    v_cvt_pk_bf16_f32 v207, v151, v155
    v_cvt_pk_bf16_f32 v208, v159, v163
    v_cvt_pk_bf16_f32 v209, v167, v171
    v_cvt_pk_bf16_f32 v210, v175, v179
    v_cvt_pk_bf16_f32 v211, v183, v187
    ds_write2_b64 v5, v[206:207], v[208:209] offset0:0 offset1:1
    ds_write_b64 v5, v[210:211] offset:16
    s_cmp_lg_u32 s63, 0
    s_cbranch_scc1 L_w1c
    s_waitcnt vmcnt(0)
    ds_write_b128 v14, v[64:67] offset:0
    ds_write_b128 v14, v[68:71] offset:256
    ds_write_b128 v14, v[72:75] offset:512
    ds_write_b128 v14, v[76:79] offset:26624
    ds_write_b128 v14, v[80:83] offset:26880
    ds_write_b128 v14, v[84:87] offset:27136
    ds_write_b128 v14, v[88:91] offset:53248
    ds_write_b128 v14, v[92:95] offset:53504
    ds_write_b128 v14, v[96:99] offset:53760
L_w1c:
    s_waitcnt lgkmcnt(0)
    s_barrier
    v_and_b32 v2, 31, v1
    v_lshrrev_b32 v3, 5, v1
    s_mul_i32 s70, s63, 19968
    v_mul_u32_u24 v4, 208, v2
    v_lshl_add_u32 v4, v3, 4, v4
    v_add_u32 v4, s70, v4
    v_bfe_u32 v5, v1, 2, 2
    v_lshl_add_u32 v5, v3, 3, v5
    v_mul_u32_u24 v5, 832, v5
    v_bfe_u32 v6, v1, 4, 1
    v_lshl_add_u32 v5, v6, 5, v5
    v_and_b32 v6, 3, v1
    v_lshl_add_u32 v5, v6, 3, v5
    s_mul_i32 s70, s62, 192
    s_add_u32 s70, s70, 46592
    v_add_u32 v5, s70, v5
    v_add_u32 v6, 39936, v5
    ds_read_b128 v[16:19], v4 offset:0
    ds_read_b64_tr_b16 v[112:113], v5 offset:0
    ds_read_b64_tr_b16 v[114:115], v5 offset:3328
    ds_read_b128 v[20:23], v4 offset:32
    ds_read_b64_tr_b16 v[116:117], v5 offset:13312
    ds_read_b64_tr_b16 v[118:119], v5 offset:16640
    ds_read_b128 v[24:27], v4 offset:64
    ds_read_b64_tr_b16 v[120:121], v5 offset:26624
    ds_read_b64_tr_b16 v[122:123], v5 offset:29952
    ds_read_b128 v[28:31], v4 offset:96
    ds_read_b64_tr_b16 v[124:125], v6 offset:0
    ds_read_b64_tr_b16 v[126:127], v6 offset:3328
    ds_read_b128 v[32:35], v4 offset:128
    ds_read_b64_tr_b16 v[128:129], v6 offset:13312
    ds_read_b64_tr_b16 v[130:131], v6 offset:16640
    ds_read_b128 v[36:39], v4 offset:160
    ds_read_b64_tr_b16 v[132:133], v6 offset:26624
    ds_read_b64_tr_b16 v[134:135], v6 offset:29952
    v_mov_b32 v7, 0
    v_lshlrev_b32 v8, 2, v0
    v_add_u32 v8, 162816, v8
    v_min_u32 v8, 163196, v8
    s_mul_i32 s70, s62, 96
    v_add_u32 v10, s70, v2
    v_mul_u32_u24 v9, 408, v10
    v_lshl_add_u32 v9, v3, 3, v9
    s_mul_i32 s70, s63, 192
    v_add_u32 v9, s70, v9
    s_mul_i32 s70, s63, 3072
    s_add_u32 s70, s70, 156672
    v_mul_u32_u24 v11, 1536, v3
    v_lshl_add_u32 v11, v10, 2, v11
    v_add_u32 v11, s70, v11
    v_mov_b32 v240, 0
    v_mov_b32 v241, 0
    v_mov_b32 v242, 0
    v_mov_b32 v243, 0
    v_mov_b32 v244, 0
    v_mov_b32 v245, 0
    v_mov_b32 v246, 0
    v_mov_b32 v247, 0
    v_mov_b32 v248, 0
    v_mov_b32 v249, 0
    v_mov_b32 v250, 0
    v_mov_b32 v251, 0
    ds_read_b64_tr_b16 v[136:137], v5 offset:64
    ds_read_b64_tr_b16 v[138:139], v5 offset:3392
    ds_read_b64_tr_b16 v[140:141], v5 offset:13376
    s_waitcnt lgkmcnt(15)
    v_mfma_f32_32x32x16_bf16 v[184:199], v[16:19], v[112:115], 0
    ds_read_b64_tr_b16 v[142:143], v5 offset:16704
    ds_read_b64_tr_b16 v[144:145], v5 offset:26688
    ds_read_b64_tr_b16 v[146:147], v5 offset:30016
    s_waitcnt lgkmcnt(15)
    v_mfma_f32_32x32x16_bf16 v[184:199], v[20:23], v[116:119], v[184:199]
    ds_read_b64_tr_b16 v[148:149], v6 offset:64
    ds_read_b64_tr_b16 v[150:151], v6 offset:3392
    ds_read_b64_tr_b16 v[152:153], v6 offset:13376
    s_waitcnt lgkmcnt(15)
    v_mfma_f32_32x32x16_bf16 v[184:199], v[24:27], v[120:123], v[184:199]
    ds_read_b64_tr_b16 v[154:155], v6 offset:16704
    ds_read_b64_tr_b16 v[156:157], v6 offset:26688
    ds_read_b64_tr_b16 v[158:159], v6 offset:30016
    s_waitcnt lgkmcnt(15)
    v_mfma_f32_32x32x16_bf16 v[184:199], v[28:31], v[124:127], v[184:199]
    ds_read_b64_tr_b16 v[160:161], v5 offset:128
    ds_read_b64_tr_b16 v[162:163], v5 offset:3456
    ds_read_b64_tr_b16 v[164:165], v5 offset:13440
    s_waitcnt lgkmcnt(15)
    v_mfma_f32_32x32x16_bf16 v[184:199], v[32:35], v[128:131], v[184:199]
    ds_read_b64_tr_b16 v[166:167], v5 offset:16768
    ds_read_b64_tr_b16 v[168:169], v5 offset:26752
    ds_read_b64_tr_b16 v[170:171], v5 offset:30080
    s_waitcnt lgkmcnt(15)
    v_mfma_f32_32x32x16_bf16 v[184:199], v[36:39], v[132:135], v[184:199]
    ds_read_b64_tr_b16 v[172:173], v6 offset:128
    ds_read_b64_tr_b16 v[174:175], v6 offset:3456
    ds_read_b64_tr_b16 v[176:177], v6 offset:13440
    ds_read_b64_tr_b16 v[178:179], v6 offset:16768
    ds_read_b64_tr_b16 v[180:181], v6 offset:26752
    ds_read_b64_tr_b16 v[182:183], v6 offset:30080
    ds_read_b128 v[40:43], v4 offset:6656
    ds_read_b128 v[44:47], v4 offset:6688
    ds_read_b128 v[48:51], v4 offset:6720
    ds_read_b128 v[52:55], v4 offset:6752
    ds_read_b128 v[56:59], v4 offset:6784
    ds_read_b128 v[60:63], v4 offset:6816
    ds_read_b128 v[64:67], v4 offset:13312
    ds_read_b128 v[68:71], v4 offset:13344
    ds_read_b128 v[72:75], v4 offset:13376
    ds_read_b128 v[76:79], v4 offset:13408
    ds_read_b128 v[80:83], v4 offset:13440
    ds_read_b128 v[84:87], v4 offset:13472
    ds_read_b128 v[88:91], v4 offset:39936
    ds_read_b128 v[92:95], v4 offset:39968
    ds_read_b128 v[96:99], v4 offset:40000
    ds_read_b128 v[100:103], v4 offset:40032
    ds_read_b128 v[104:107], v4 offset:40064
    ds_read_b128 v[108:111], v4 offset:40096
    ds_write_b32 v8, v7
    v_lshrrev_b32 v2, 2, v0
    v_and_b32 v3, 3, v0
    v_mul_u32_u24 v4, 192, v2
    v_mul_u32_u24 v5, 48, v3
    v_add_u32 v4, v4, v5
    v_lshlrev_b32 v6, 1, v2
    v_lshlrev_b32 v8, 2, v1
    v_mul_u32_u24 v10, 408, v2
    v_add_u32 v10, v10, v5
    v_lshlrev_b32 v7, 2, v2
    v_add_u32 v7, 156672, v7
    v_mov_b32 v12, 0
    s_mov_b32 s70, 24576
    s_mov_b32 s71, 49152
    v_pk_fma_f32 v[216:217], v[184:185], v[184:185], s[68:69]
    v_pk_fma_f32 v[218:219], v[186:187], v[186:187], s[68:69]
    v_pk_fma_f32 v[220:221], v[188:189], v[188:189], s[68:69]
    v_pk_fma_f32 v[222:223], v[190:191], v[190:191], s[68:69]
    v_pk_fma_f32 v[224:225], v[192:193], v[192:193], s[68:69]
    v_pk_fma_f32 v[226:227], v[194:195], v[194:195], s[68:69]
    v_pk_fma_f32 v[228:229], v[196:197], v[196:197], s[68:69]
    v_pk_fma_f32 v[230:231], v[198:199], v[198:199], s[68:69]
    v_pk_mul_f32 v[216:217], v[216:217], v[184:185]
    v_pk_mul_f32 v[218:219], v[218:219], v[186:187]
    v_pk_mul_f32 v[220:221], v[220:221], v[188:189]
    v_pk_mul_f32 v[222:223], v[222:223], v[190:191]
    v_pk_mul_f32 v[224:225], v[224:225], v[192:193]
    v_pk_mul_f32 v[226:227], v[226:227], v[194:195]
    v_pk_mul_f32 v[228:229], v[228:229], v[196:197]
    v_pk_mul_f32 v[230:231], v[230:231], v[198:199]
    s_waitcnt lgkmcnt(0)
    v_mfma_f32_32x32x16_bf16 v[200:215], v[16:19], v[136:139], 0
    v_exp_f32 v216, v216
    v_exp_f32 v217, v217
    v_exp_f32 v218, v218
    v_exp_f32 v219, v219
    v_mfma_f32_32x32x16_bf16 v[200:215], v[20:23], v[140:143], v[200:215]
    v_exp_f32 v220, v220
    v_exp_f32 v221, v221
    v_exp_f32 v222, v222
    v_exp_f32 v223, v223
    v_mfma_f32_32x32x16_bf16 v[200:215], v[24:27], v[144:147], v[200:215]
    v_exp_f32 v224, v224
    v_exp_f32 v225, v225
    v_exp_f32 v226, v226
    v_exp_f32 v227, v227
    v_mfma_f32_32x32x16_bf16 v[200:215], v[28:31], v[148:151], v[200:215]
    v_exp_f32 v228, v228
    v_exp_f32 v229, v229
    v_exp_f32 v230, v230
    v_exp_f32 v231, v231
    v_pk_add_f32 v[216:217], v[216:217], 1.0 op_sel_hi:[1,0]
    v_pk_add_f32 v[218:219], v[218:219], 1.0 op_sel_hi:[1,0]
    v_pk_add_f32 v[220:221], v[220:221], 1.0 op_sel_hi:[1,0]
    v_pk_add_f32 v[222:223], v[222:223], 1.0 op_sel_hi:[1,0]
    v_pk_add_f32 v[224:225], v[224:225], 1.0 op_sel_hi:[1,0]
    v_pk_add_f32 v[226:227], v[226:227], 1.0 op_sel_hi:[1,0]
    v_pk_add_f32 v[228:229], v[228:229], 1.0 op_sel_hi:[1,0]
    v_pk_add_f32 v[230:231], v[230:231], 1.0 op_sel_hi:[1,0]
    v_mfma_f32_32x32x16_bf16 v[200:215], v[32:35], v[152:155], v[200:215]
    v_rcp_f32 v216, v216
    v_rcp_f32 v217, v217
    v_rcp_f32 v218, v218
    v_rcp_f32 v219, v219
    v_mfma_f32_32x32x16_bf16 v[200:215], v[36:39], v[156:159], v[200:215]
    v_rcp_f32 v220, v220
    v_rcp_f32 v221, v221
    v_rcp_f32 v222, v222
    v_rcp_f32 v223, v223
    v_rcp_f32 v224, v224
    v_rcp_f32 v225, v225
    v_rcp_f32 v226, v226
    v_rcp_f32 v227, v227
    v_rcp_f32 v228, v228
    v_rcp_f32 v229, v229
    v_rcp_f32 v230, v230
    v_rcp_f32 v231, v231
    v_pk_mul_f32 v[216:217], v[216:217], v[184:185]
    v_pk_mul_f32 v[218:219], v[218:219], v[186:187]
    v_pk_mul_f32 v[220:221], v[220:221], v[188:189]
    v_pk_mul_f32 v[222:223], v[222:223], v[190:191]
    v_pk_mul_f32 v[224:225], v[224:225], v[192:193]
    v_pk_mul_f32 v[226:227], v[226:227], v[194:195]
    v_pk_mul_f32 v[228:229], v[228:229], v[196:197]
    v_pk_mul_f32 v[230:231], v[230:231], v[198:199]
    s_barrier
    v_pk_fma_f32 v[240:241], v[216:217], v[216:217], v[240:241]
    v_cvt_pk_bf16_f32 v232, v216, v217
    v_pk_fma_f32 v[216:217], v[200:201], v[200:201], s[68:69]
    v_pk_fma_f32 v[242:243], v[218:219], v[218:219], v[242:243]
    v_cvt_pk_bf16_f32 v233, v218, v219
    v_pk_fma_f32 v[218:219], v[202:203], v[202:203], s[68:69]
    ds_write_b64 v9, v[232:233] offset:0
    v_pk_fma_f32 v[240:241], v[220:221], v[220:221], v[240:241]
    v_cvt_pk_bf16_f32 v234, v220, v221
    v_pk_fma_f32 v[220:221], v[204:205], v[204:205], s[68:69]
    v_pk_fma_f32 v[242:243], v[222:223], v[222:223], v[242:243]
    v_cvt_pk_bf16_f32 v235, v222, v223
    v_pk_fma_f32 v[222:223], v[206:207], v[206:207], s[68:69]
    ds_write_b64 v9, v[234:235] offset:16
    v_pk_fma_f32 v[240:241], v[224:225], v[224:225], v[240:241]
    v_cvt_pk_bf16_f32 v236, v224, v225
    v_pk_fma_f32 v[224:225], v[208:209], v[208:209], s[68:69]
    v_pk_fma_f32 v[242:243], v[226:227], v[226:227], v[242:243]
    v_cvt_pk_bf16_f32 v237, v226, v227
    v_pk_fma_f32 v[226:227], v[210:211], v[210:211], s[68:69]
    ds_write_b64 v9, v[236:237] offset:32
    v_pk_fma_f32 v[240:241], v[228:229], v[228:229], v[240:241]
    v_cvt_pk_bf16_f32 v238, v228, v229
    v_pk_fma_f32 v[228:229], v[212:213], v[212:213], s[68:69]
    v_pk_fma_f32 v[242:243], v[230:231], v[230:231], v[242:243]
    v_cvt_pk_bf16_f32 v239, v230, v231
    v_pk_fma_f32 v[230:231], v[214:215], v[214:215], s[68:69]
    ds_write_b64 v9, v[238:239] offset:48
    v_pk_mul_f32 v[216:217], v[216:217], v[200:201]
    v_pk_mul_f32 v[218:219], v[218:219], v[202:203]
    v_pk_mul_f32 v[220:221], v[220:221], v[204:205]
    v_pk_mul_f32 v[222:223], v[222:223], v[206:207]
    v_pk_mul_f32 v[224:225], v[224:225], v[208:209]
    v_pk_mul_f32 v[226:227], v[226:227], v[210:211]
    v_pk_mul_f32 v[228:229], v[228:229], v[212:213]
    v_pk_mul_f32 v[230:231], v[230:231], v[214:215]
    v_mfma_f32_32x32x16_bf16 v[184:199], v[16:19], v[160:163], 0
    v_exp_f32 v216, v216
    v_exp_f32 v217, v217
    v_exp_f32 v218, v218
    v_exp_f32 v219, v219
    v_mfma_f32_32x32x16_bf16 v[184:199], v[20:23], v[164:167], v[184:199]
    v_exp_f32 v220, v220
    v_exp_f32 v221, v221
    v_exp_f32 v222, v222
    v_exp_f32 v223, v223
    v_mfma_f32_32x32x16_bf16 v[184:199], v[24:27], v[168:171], v[184:199]
    v_exp_f32 v224, v224
    v_exp_f32 v225, v225
    v_exp_f32 v226, v226
    v_exp_f32 v227, v227
    v_mfma_f32_32x32x16_bf16 v[184:199], v[28:31], v[172:175], v[184:199]
    v_exp_f32 v228, v228
    v_exp_f32 v229, v229
    v_exp_f32 v230, v230
    v_exp_f32 v231, v231
    v_pk_add_f32 v[216:217], v[216:217], 1.0 op_sel_hi:[1,0]
    v_pk_add_f32 v[218:219], v[218:219], 1.0 op_sel_hi:[1,0]
    v_pk_add_f32 v[220:221], v[220:221], 1.0 op_sel_hi:[1,0]
    v_pk_add_f32 v[222:223], v[222:223], 1.0 op_sel_hi:[1,0]
    v_pk_add_f32 v[224:225], v[224:225], 1.0 op_sel_hi:[1,0]
    v_pk_add_f32 v[226:227], v[226:227], 1.0 op_sel_hi:[1,0]
    v_pk_add_f32 v[228:229], v[228:229], 1.0 op_sel_hi:[1,0]
    v_pk_add_f32 v[230:231], v[230:231], 1.0 op_sel_hi:[1,0]
    v_mfma_f32_32x32x16_bf16 v[184:199], v[32:35], v[176:179], v[184:199]
    v_rcp_f32 v216, v216
    v_rcp_f32 v217, v217
    v_rcp_f32 v218, v218
    v_rcp_f32 v219, v219
    v_mfma_f32_32x32x16_bf16 v[184:199], v[36:39], v[180:183], v[184:199]
    v_rcp_f32 v220, v220
    v_rcp_f32 v221, v221
    v_rcp_f32 v222, v222
    v_rcp_f32 v223, v223
    v_rcp_f32 v224, v224
    v_rcp_f32 v225, v225
    v_rcp_f32 v226, v226
    v_rcp_f32 v227, v227
    v_rcp_f32 v228, v228
    v_rcp_f32 v229, v229
    v_rcp_f32 v230, v230
    v_rcp_f32 v231, v231
    v_pk_mul_f32 v[216:217], v[216:217], v[200:201]
    v_pk_mul_f32 v[218:219], v[218:219], v[202:203]
    v_pk_mul_f32 v[220:221], v[220:221], v[204:205]
    v_pk_mul_f32 v[222:223], v[222:223], v[206:207]
    v_pk_mul_f32 v[224:225], v[224:225], v[208:209]
    v_pk_mul_f32 v[226:227], v[226:227], v[210:211]
    v_pk_mul_f32 v[228:229], v[228:229], v[212:213]
    v_pk_mul_f32 v[230:231], v[230:231], v[214:215]
    v_pk_fma_f32 v[244:245], v[216:217], v[216:217], v[244:245]
    v_cvt_pk_bf16_f32 v232, v216, v217
    v_pk_fma_f32 v[216:217], v[184:185], v[184:185], s[68:69]
    v_pk_fma_f32 v[246:247], v[218:219], v[218:219], v[246:247]
    v_cvt_pk_bf16_f32 v233, v218, v219
    v_pk_fma_f32 v[218:219], v[186:187], v[186:187], s[68:69]
    ds_write_b64 v9, v[232:233] offset:13056
    v_pk_fma_f32 v[244:245], v[220:221], v[220:221], v[244:245]
    v_cvt_pk_bf16_f32 v234, v220, v221
    v_pk_fma_f32 v[220:221], v[188:189], v[188:189], s[68:69]
    v_pk_fma_f32 v[246:247], v[222:223], v[222:223], v[246:247]
    v_cvt_pk_bf16_f32 v235, v222, v223
    v_pk_fma_f32 v[222:223], v[190:191], v[190:191], s[68:69]
    ds_write_b64 v9, v[234:235] offset:13072
    v_pk_fma_f32 v[244:245], v[224:225], v[224:225], v[244:245]
    v_cvt_pk_bf16_f32 v236, v224, v225
    v_pk_fma_f32 v[224:225], v[192:193], v[192:193], s[68:69]
    v_pk_fma_f32 v[246:247], v[226:227], v[226:227], v[246:247]
    v_cvt_pk_bf16_f32 v237, v226, v227
    v_pk_fma_f32 v[226:227], v[194:195], v[194:195], s[68:69]
    ds_write_b64 v9, v[236:237] offset:13088
    v_pk_fma_f32 v[244:245], v[228:229], v[228:229], v[244:245]
    v_cvt_pk_bf16_f32 v238, v228, v229
    v_pk_fma_f32 v[228:229], v[196:197], v[196:197], s[68:69]
    v_pk_fma_f32 v[246:247], v[230:231], v[230:231], v[246:247]
    v_cvt_pk_bf16_f32 v239, v230, v231
    v_pk_fma_f32 v[230:231], v[198:199], v[198:199], s[68:69]
    ds_write_b64 v9, v[238:239] offset:13104
    v_pk_mul_f32 v[216:217], v[216:217], v[184:185]
    v_pk_mul_f32 v[218:219], v[218:219], v[186:187]
    v_pk_mul_f32 v[220:221], v[220:221], v[188:189]
    v_pk_mul_f32 v[222:223], v[222:223], v[190:191]
    v_pk_mul_f32 v[224:225], v[224:225], v[192:193]
    v_pk_mul_f32 v[226:227], v[226:227], v[194:195]
    v_pk_mul_f32 v[228:229], v[228:229], v[196:197]
    v_pk_mul_f32 v[230:231], v[230:231], v[198:199]
    v_mfma_f32_32x32x16_bf16 v[200:215], v[40:43], v[112:115], 0
    v_exp_f32 v216, v216
    v_exp_f32 v217, v217
    v_exp_f32 v218, v218
    v_exp_f32 v219, v219
    v_mfma_f32_32x32x16_bf16 v[200:215], v[44:47], v[116:119], v[200:215]
    v_exp_f32 v220, v220
    v_exp_f32 v221, v221
    v_exp_f32 v222, v222
    v_exp_f32 v223, v223
    v_mfma_f32_32x32x16_bf16 v[200:215], v[48:51], v[120:123], v[200:215]
    v_exp_f32 v224, v224
    v_exp_f32 v225, v225
    v_exp_f32 v226, v226
    v_exp_f32 v227, v227
    v_mfma_f32_32x32x16_bf16 v[200:215], v[52:55], v[124:127], v[200:215]
    v_exp_f32 v228, v228
    v_exp_f32 v229, v229
    v_exp_f32 v230, v230
    v_exp_f32 v231, v231
    v_pk_add_f32 v[216:217], v[216:217], 1.0 op_sel_hi:[1,0]
    v_pk_add_f32 v[218:219], v[218:219], 1.0 op_sel_hi:[1,0]
    v_pk_add_f32 v[220:221], v[220:221], 1.0 op_sel_hi:[1,0]
    v_pk_add_f32 v[222:223], v[222:223], 1.0 op_sel_hi:[1,0]
    v_pk_add_f32 v[224:225], v[224:225], 1.0 op_sel_hi:[1,0]
    v_pk_add_f32 v[226:227], v[226:227], 1.0 op_sel_hi:[1,0]
    v_pk_add_f32 v[228:229], v[228:229], 1.0 op_sel_hi:[1,0]
    v_pk_add_f32 v[230:231], v[230:231], 1.0 op_sel_hi:[1,0]
    v_mfma_f32_32x32x16_bf16 v[200:215], v[56:59], v[128:131], v[200:215]
    v_rcp_f32 v216, v216
    v_rcp_f32 v217, v217
    v_rcp_f32 v218, v218
    v_rcp_f32 v219, v219
    v_mfma_f32_32x32x16_bf16 v[200:215], v[60:63], v[132:135], v[200:215]
    v_rcp_f32 v220, v220
    v_rcp_f32 v221, v221
    v_rcp_f32 v222, v222
    v_rcp_f32 v223, v223
    v_mfma_f32_32x32x16_bf16 v[16:31], v[88:91], v[112:115], 0
    v_rcp_f32 v224, v224
    v_rcp_f32 v225, v225
    v_rcp_f32 v226, v226
    v_rcp_f32 v227, v227
    v_mfma_f32_32x32x16_bf16 v[16:31], v[92:95], v[116:119], v[16:31]
    v_rcp_f32 v228, v228
    v_rcp_f32 v229, v229
    v_rcp_f32 v230, v230
    v_rcp_f32 v231, v231
    v_pk_mul_f32 v[216:217], v[216:217], v[184:185]
    v_pk_mul_f32 v[218:219], v[218:219], v[186:187]
    v_pk_mul_f32 v[220:221], v[220:221], v[188:189]
    v_pk_mul_f32 v[222:223], v[222:223], v[190:191]
    v_pk_mul_f32 v[224:225], v[224:225], v[192:193]
    v_pk_mul_f32 v[226:227], v[226:227], v[194:195]
    v_pk_mul_f32 v[228:229], v[228:229], v[196:197]
    v_pk_mul_f32 v[230:231], v[230:231], v[198:199]
    v_pk_fma_f32 v[248:249], v[216:217], v[216:217], v[248:249]
    v_cvt_pk_bf16_f32 v232, v216, v217
    v_pk_fma_f32 v[216:217], v[200:201], v[200:201], s[68:69]
    v_pk_fma_f32 v[250:251], v[218:219], v[218:219], v[250:251]
    v_cvt_pk_bf16_f32 v233, v218, v219
    v_pk_fma_f32 v[218:219], v[202:203], v[202:203], s[68:69]
    ds_write_b64 v9, v[232:233] offset:26112
    v_pk_fma_f32 v[248:249], v[220:221], v[220:221], v[248:249]
    v_cvt_pk_bf16_f32 v234, v220, v221
    v_pk_fma_f32 v[220:221], v[204:205], v[204:205], s[68:69]
    v_pk_fma_f32 v[250:251], v[222:223], v[222:223], v[250:251]
    v_cvt_pk_bf16_f32 v235, v222, v223
    v_pk_fma_f32 v[222:223], v[206:207], v[206:207], s[68:69]
    ds_write_b64 v9, v[234:235] offset:26128
    v_pk_fma_f32 v[248:249], v[224:225], v[224:225], v[248:249]
    v_cvt_pk_bf16_f32 v236, v224, v225
    v_pk_fma_f32 v[224:225], v[208:209], v[208:209], s[68:69]
    v_pk_fma_f32 v[250:251], v[226:227], v[226:227], v[250:251]
    v_cvt_pk_bf16_f32 v237, v226, v227
    v_pk_fma_f32 v[226:227], v[210:211], v[210:211], s[68:69]
    ds_write_b64 v9, v[236:237] offset:26144
    v_pk_fma_f32 v[248:249], v[228:229], v[228:229], v[248:249]
    v_cvt_pk_bf16_f32 v238, v228, v229
    v_pk_fma_f32 v[228:229], v[212:213], v[212:213], s[68:69]
    v_pk_fma_f32 v[250:251], v[230:231], v[230:231], v[250:251]
    v_cvt_pk_bf16_f32 v239, v230, v231
    v_pk_fma_f32 v[230:231], v[214:215], v[214:215], s[68:69]
    ds_write_b64 v9, v[238:239] offset:26160
    v_pk_mul_f32 v[216:217], v[216:217], v[200:201]
    v_pk_mul_f32 v[218:219], v[218:219], v[202:203]
    v_pk_mul_f32 v[220:221], v[220:221], v[204:205]
    v_pk_mul_f32 v[222:223], v[222:223], v[206:207]
    v_pk_mul_f32 v[224:225], v[224:225], v[208:209]
    v_pk_mul_f32 v[226:227], v[226:227], v[210:211]
    v_pk_mul_f32 v[228:229], v[228:229], v[212:213]
    v_pk_mul_f32 v[230:231], v[230:231], v[214:215]
    v_mfma_f32_32x32x16_bf16 v[184:199], v[40:43], v[136:139], 0
    v_exp_f32 v216, v216
    v_exp_f32 v217, v217
    v_exp_f32 v218, v218
    v_exp_f32 v219, v219
    v_mfma_f32_32x32x16_bf16 v[184:199], v[44:47], v[140:143], v[184:199]
    v_exp_f32 v220, v220
    v_exp_f32 v221, v221
    v_exp_f32 v222, v222
    v_exp_f32 v223, v223
    v_mfma_f32_32x32x16_bf16 v[184:199], v[48:51], v[144:147], v[184:199]
    v_exp_f32 v224, v224
    v_exp_f32 v225, v225
    v_exp_f32 v226, v226
    v_exp_f32 v227, v227
    v_mfma_f32_32x32x16_bf16 v[184:199], v[52:55], v[148:151], v[184:199]
    v_exp_f32 v228, v228
    v_exp_f32 v229, v229
    v_exp_f32 v230, v230
    v_exp_f32 v231, v231
    v_pk_add_f32 v[216:217], v[216:217], 1.0 op_sel_hi:[1,0]
    v_pk_add_f32 v[218:219], v[218:219], 1.0 op_sel_hi:[1,0]
    v_pk_add_f32 v[220:221], v[220:221], 1.0 op_sel_hi:[1,0]
    v_pk_add_f32 v[222:223], v[222:223], 1.0 op_sel_hi:[1,0]
    v_pk_add_f32 v[224:225], v[224:225], 1.0 op_sel_hi:[1,0]
    v_pk_add_f32 v[226:227], v[226:227], 1.0 op_sel_hi:[1,0]
    v_pk_add_f32 v[228:229], v[228:229], 1.0 op_sel_hi:[1,0]
    v_pk_add_f32 v[230:231], v[230:231], 1.0 op_sel_hi:[1,0]
    v_mfma_f32_32x32x16_bf16 v[184:199], v[56:59], v[152:155], v[184:199]
    v_rcp_f32 v216, v216
    v_rcp_f32 v217, v217
    v_rcp_f32 v218, v218
    v_rcp_f32 v219, v219
    v_mfma_f32_32x32x16_bf16 v[184:199], v[60:63], v[156:159], v[184:199]
    v_rcp_f32 v220, v220
    v_rcp_f32 v221, v221
    v_rcp_f32 v222, v222
    v_rcp_f32 v223, v223
    v_mfma_f32_32x32x16_bf16 v[16:31], v[96:99], v[120:123], v[16:31]
    v_rcp_f32 v224, v224
    v_rcp_f32 v225, v225
    v_rcp_f32 v226, v226
    v_rcp_f32 v227, v227
    v_mfma_f32_32x32x16_bf16 v[16:31], v[100:103], v[124:127], v[16:31]
    v_rcp_f32 v228, v228
    v_rcp_f32 v229, v229
    v_rcp_f32 v230, v230
    v_rcp_f32 v231, v231
    v_pk_mul_f32 v[216:217], v[216:217], v[200:201]
    v_pk_mul_f32 v[218:219], v[218:219], v[202:203]
    v_pk_mul_f32 v[220:221], v[220:221], v[204:205]
    v_pk_mul_f32 v[222:223], v[222:223], v[206:207]
    v_pk_mul_f32 v[224:225], v[224:225], v[208:209]
    v_pk_mul_f32 v[226:227], v[226:227], v[210:211]
    v_pk_mul_f32 v[228:229], v[228:229], v[212:213]
    v_pk_mul_f32 v[230:231], v[230:231], v[214:215]
    v_pk_fma_f32 v[240:241], v[216:217], v[216:217], v[240:241]
    v_cvt_pk_bf16_f32 v232, v216, v217
    v_pk_fma_f32 v[216:217], v[184:185], v[184:185], s[68:69]
    v_pk_fma_f32 v[242:243], v[218:219], v[218:219], v[242:243]
    v_cvt_pk_bf16_f32 v233, v218, v219
    v_pk_fma_f32 v[218:219], v[186:187], v[186:187], s[68:69]
    ds_write_b64 v9, v[232:233] offset:64
    v_pk_fma_f32 v[240:241], v[220:221], v[220:221], v[240:241]
    v_cvt_pk_bf16_f32 v234, v220, v221
    v_pk_fma_f32 v[220:221], v[188:189], v[188:189], s[68:69]
    v_pk_fma_f32 v[242:243], v[222:223], v[222:223], v[242:243]
    v_cvt_pk_bf16_f32 v235, v222, v223
    v_pk_fma_f32 v[222:223], v[190:191], v[190:191], s[68:69]
    ds_write_b64 v9, v[234:235] offset:80
    v_pk_fma_f32 v[240:241], v[224:225], v[224:225], v[240:241]
    v_cvt_pk_bf16_f32 v236, v224, v225
    v_pk_fma_f32 v[224:225], v[192:193], v[192:193], s[68:69]
    v_pk_fma_f32 v[242:243], v[226:227], v[226:227], v[242:243]
    v_cvt_pk_bf16_f32 v237, v226, v227
    v_pk_fma_f32 v[226:227], v[194:195], v[194:195], s[68:69]
    ds_write_b64 v9, v[236:237] offset:96
    v_pk_fma_f32 v[240:241], v[228:229], v[228:229], v[240:241]
    v_cvt_pk_bf16_f32 v238, v228, v229
    v_pk_fma_f32 v[228:229], v[196:197], v[196:197], s[68:69]
    v_pk_fma_f32 v[242:243], v[230:231], v[230:231], v[242:243]
    v_cvt_pk_bf16_f32 v239, v230, v231
    v_pk_fma_f32 v[230:231], v[198:199], v[198:199], s[68:69]
    ds_write_b64 v9, v[238:239] offset:112
    v_pk_mul_f32 v[216:217], v[216:217], v[184:185]
    v_pk_mul_f32 v[218:219], v[218:219], v[186:187]
    v_pk_mul_f32 v[220:221], v[220:221], v[188:189]
    v_pk_mul_f32 v[222:223], v[222:223], v[190:191]
    v_pk_mul_f32 v[224:225], v[224:225], v[192:193]
    v_pk_mul_f32 v[226:227], v[226:227], v[194:195]
    v_pk_mul_f32 v[228:229], v[228:229], v[196:197]
    v_pk_mul_f32 v[230:231], v[230:231], v[198:199]
    v_mfma_f32_32x32x16_bf16 v[200:215], v[40:43], v[160:163], 0
    v_exp_f32 v216, v216
    v_exp_f32 v217, v217
    v_exp_f32 v218, v218
    v_exp_f32 v219, v219
    v_mfma_f32_32x32x16_bf16 v[200:215], v[44:47], v[164:167], v[200:215]
    v_exp_f32 v220, v220
    v_exp_f32 v221, v221
    v_exp_f32 v222, v222
    v_exp_f32 v223, v223
    v_mfma_f32_32x32x16_bf16 v[200:215], v[48:51], v[168:171], v[200:215]
    v_exp_f32 v224, v224
    v_exp_f32 v225, v225
    v_exp_f32 v226, v226
    v_exp_f32 v227, v227
    v_mfma_f32_32x32x16_bf16 v[200:215], v[52:55], v[172:175], v[200:215]
    v_exp_f32 v228, v228
    v_exp_f32 v229, v229
    v_exp_f32 v230, v230
    v_exp_f32 v231, v231
    v_pk_add_f32 v[216:217], v[216:217], 1.0 op_sel_hi:[1,0]
    v_pk_add_f32 v[218:219], v[218:219], 1.0 op_sel_hi:[1,0]
    v_pk_add_f32 v[220:221], v[220:221], 1.0 op_sel_hi:[1,0]
    v_pk_add_f32 v[222:223], v[222:223], 1.0 op_sel_hi:[1,0]
    v_pk_add_f32 v[224:225], v[224:225], 1.0 op_sel_hi:[1,0]
    v_pk_add_f32 v[226:227], v[226:227], 1.0 op_sel_hi:[1,0]
    v_pk_add_f32 v[228:229], v[228:229], 1.0 op_sel_hi:[1,0]
    v_pk_add_f32 v[230:231], v[230:231], 1.0 op_sel_hi:[1,0]
    v_mfma_f32_32x32x16_bf16 v[200:215], v[56:59], v[176:179], v[200:215]
    v_rcp_f32 v216, v216
    v_rcp_f32 v217, v217
    v_rcp_f32 v218, v218
    v_rcp_f32 v219, v219
    v_mfma_f32_32x32x16_bf16 v[200:215], v[60:63], v[180:183], v[200:215]
    v_rcp_f32 v220, v220
    v_rcp_f32 v221, v221
    v_rcp_f32 v222, v222
    v_rcp_f32 v223, v223
    v_mfma_f32_32x32x16_bf16 v[16:31], v[104:107], v[128:131], v[16:31]
    v_rcp_f32 v224, v224
    v_rcp_f32 v225, v225
    v_rcp_f32 v226, v226
    v_rcp_f32 v227, v227
    v_mfma_f32_32x32x16_bf16 v[16:31], v[108:111], v[132:135], v[16:31]
    v_rcp_f32 v228, v228
    v_rcp_f32 v229, v229
    v_rcp_f32 v230, v230
    v_rcp_f32 v231, v231
    v_pk_mul_f32 v[216:217], v[216:217], v[184:185]
    v_pk_mul_f32 v[218:219], v[218:219], v[186:187]
    v_pk_mul_f32 v[220:221], v[220:221], v[188:189]
    v_pk_mul_f32 v[222:223], v[222:223], v[190:191]
    v_pk_mul_f32 v[224:225], v[224:225], v[192:193]
    v_pk_mul_f32 v[226:227], v[226:227], v[194:195]
    v_pk_mul_f32 v[228:229], v[228:229], v[196:197]
    v_pk_mul_f32 v[230:231], v[230:231], v[198:199]
    v_pk_fma_f32 v[244:245], v[216:217], v[216:217], v[244:245]
    v_cvt_pk_bf16_f32 v232, v216, v217
    v_pk_fma_f32 v[216:217], v[200:201], v[200:201], s[68:69]
    v_pk_fma_f32 v[246:247], v[218:219], v[218:219], v[246:247]
    v_cvt_pk_bf16_f32 v233, v218, v219
    v_pk_fma_f32 v[218:219], v[202:203], v[202:203], s[68:69]
    ds_write_b64 v9, v[232:233] offset:13120
    v_pk_fma_f32 v[244:245], v[220:221], v[220:221], v[244:245]
    v_cvt_pk_bf16_f32 v234, v220, v221
    v_pk_fma_f32 v[220:221], v[204:205], v[204:205], s[68:69]
    v_pk_fma_f32 v[246:247], v[222:223], v[222:223], v[246:247]
    v_cvt_pk_bf16_f32 v235, v222, v223
    v_pk_fma_f32 v[222:223], v[206:207], v[206:207], s[68:69]
    ds_write_b64 v9, v[234:235] offset:13136
    v_pk_fma_f32 v[244:245], v[224:225], v[224:225], v[244:245]
    v_cvt_pk_bf16_f32 v236, v224, v225
    v_pk_fma_f32 v[224:225], v[208:209], v[208:209], s[68:69]
    v_pk_fma_f32 v[246:247], v[226:227], v[226:227], v[246:247]
    v_cvt_pk_bf16_f32 v237, v226, v227
    v_pk_fma_f32 v[226:227], v[210:211], v[210:211], s[68:69]
    ds_write_b64 v9, v[236:237] offset:13152
    v_pk_fma_f32 v[244:245], v[228:229], v[228:229], v[244:245]
    v_cvt_pk_bf16_f32 v238, v228, v229
    v_pk_fma_f32 v[228:229], v[212:213], v[212:213], s[68:69]
    v_pk_fma_f32 v[246:247], v[230:231], v[230:231], v[246:247]
    v_cvt_pk_bf16_f32 v239, v230, v231
    v_pk_fma_f32 v[230:231], v[214:215], v[214:215], s[68:69]
    ds_write_b64 v9, v[238:239] offset:13168
    v_pk_mul_f32 v[216:217], v[216:217], v[200:201]
    v_pk_mul_f32 v[218:219], v[218:219], v[202:203]
    v_pk_mul_f32 v[220:221], v[220:221], v[204:205]
    v_pk_mul_f32 v[222:223], v[222:223], v[206:207]
    v_pk_mul_f32 v[224:225], v[224:225], v[208:209]
    v_pk_mul_f32 v[226:227], v[226:227], v[210:211]
    v_pk_mul_f32 v[228:229], v[228:229], v[212:213]
    v_pk_mul_f32 v[230:231], v[230:231], v[214:215]
    v_mfma_f32_32x32x16_bf16 v[184:199], v[64:67], v[112:115], 0
    v_exp_f32 v216, v216
    v_exp_f32 v217, v217
    v_exp_f32 v218, v218
    v_exp_f32 v219, v219
    v_mfma_f32_32x32x16_bf16 v[184:199], v[68:71], v[116:119], v[184:199]
    v_exp_f32 v220, v220
    v_exp_f32 v221, v221
    v_exp_f32 v222, v222
    v_exp_f32 v223, v223
    v_mfma_f32_32x32x16_bf16 v[184:199], v[72:75], v[120:123], v[184:199]
    v_exp_f32 v224, v224
    v_exp_f32 v225, v225
    v_exp_f32 v226, v226
    v_exp_f32 v227, v227
    v_mfma_f32_32x32x16_bf16 v[184:199], v[76:79], v[124:127], v[184:199]
    v_exp_f32 v228, v228
    v_exp_f32 v229, v229
    v_exp_f32 v230, v230
    v_exp_f32 v231, v231
    v_pk_add_f32 v[216:217], v[216:217], 1.0 op_sel_hi:[1,0]
    v_pk_add_f32 v[218:219], v[218:219], 1.0 op_sel_hi:[1,0]
    v_pk_add_f32 v[220:221], v[220:221], 1.0 op_sel_hi:[1,0]
    v_pk_add_f32 v[222:223], v[222:223], 1.0 op_sel_hi:[1,0]
    v_pk_add_f32 v[224:225], v[224:225], 1.0 op_sel_hi:[1,0]
    v_pk_add_f32 v[226:227], v[226:227], 1.0 op_sel_hi:[1,0]
    v_pk_add_f32 v[228:229], v[228:229], 1.0 op_sel_hi:[1,0]
    v_pk_add_f32 v[230:231], v[230:231], 1.0 op_sel_hi:[1,0]
    v_mfma_f32_32x32x16_bf16 v[184:199], v[80:83], v[128:131], v[184:199]
    v_rcp_f32 v216, v216
    v_rcp_f32 v217, v217
    v_rcp_f32 v218, v218
    v_rcp_f32 v219, v219
    v_mfma_f32_32x32x16_bf16 v[184:199], v[84:87], v[132:135], v[184:199]
    v_rcp_f32 v220, v220
    v_rcp_f32 v221, v221
    v_rcp_f32 v222, v222
    v_rcp_f32 v223, v223
    v_mfma_f32_32x32x16_bf16 v[32:47], v[88:91], v[136:139], 0
    v_rcp_f32 v224, v224
    v_rcp_f32 v225, v225
    v_rcp_f32 v226, v226
    v_rcp_f32 v227, v227
    v_mfma_f32_32x32x16_bf16 v[32:47], v[92:95], v[140:143], v[32:47]
    v_rcp_f32 v228, v228
    v_rcp_f32 v229, v229
    v_rcp_f32 v230, v230
    v_rcp_f32 v231, v231
    v_pk_mul_f32 v[216:217], v[216:217], v[200:201]
    v_pk_mul_f32 v[218:219], v[218:219], v[202:203]
    v_pk_mul_f32 v[220:221], v[220:221], v[204:205]
    v_pk_mul_f32 v[222:223], v[222:223], v[206:207]
    v_pk_mul_f32 v[224:225], v[224:225], v[208:209]
    v_pk_mul_f32 v[226:227], v[226:227], v[210:211]
    v_pk_mul_f32 v[228:229], v[228:229], v[212:213]
    v_pk_mul_f32 v[230:231], v[230:231], v[214:215]
    v_pk_fma_f32 v[248:249], v[216:217], v[216:217], v[248:249]
    v_cvt_pk_bf16_f32 v232, v216, v217
    v_pk_fma_f32 v[216:217], v[184:185], v[184:185], s[68:69]
    v_pk_fma_f32 v[250:251], v[218:219], v[218:219], v[250:251]
    v_cvt_pk_bf16_f32 v233, v218, v219
    v_pk_fma_f32 v[218:219], v[186:187], v[186:187], s[68:69]
    ds_write_b64 v9, v[232:233] offset:26176
    v_pk_fma_f32 v[248:249], v[220:221], v[220:221], v[248:249]
    v_cvt_pk_bf16_f32 v234, v220, v221
    v_pk_fma_f32 v[220:221], v[188:189], v[188:189], s[68:69]
    v_pk_fma_f32 v[250:251], v[222:223], v[222:223], v[250:251]
    v_cvt_pk_bf16_f32 v235, v222, v223
    v_pk_fma_f32 v[222:223], v[190:191], v[190:191], s[68:69]
    ds_write_b64 v9, v[234:235] offset:26192
    v_pk_fma_f32 v[248:249], v[224:225], v[224:225], v[248:249]
    v_cvt_pk_bf16_f32 v236, v224, v225
    v_pk_fma_f32 v[224:225], v[192:193], v[192:193], s[68:69]
    v_pk_fma_f32 v[250:251], v[226:227], v[226:227], v[250:251]
    v_cvt_pk_bf16_f32 v237, v226, v227
    v_pk_fma_f32 v[226:227], v[194:195], v[194:195], s[68:69]
    ds_write_b64 v9, v[236:237] offset:26208
    v_pk_fma_f32 v[248:249], v[228:229], v[228:229], v[248:249]
    v_cvt_pk_bf16_f32 v238, v228, v229
    v_pk_fma_f32 v[228:229], v[196:197], v[196:197], s[68:69]
    v_pk_fma_f32 v[250:251], v[230:231], v[230:231], v[250:251]
    v_cvt_pk_bf16_f32 v239, v230, v231
    v_pk_fma_f32 v[230:231], v[198:199], v[198:199], s[68:69]
    ds_write_b64 v9, v[238:239] offset:26224
    buffer_load_dwordx4 v[112:115], v4, s[36:39], 0 offen offset:0
    buffer_load_dwordx4 v[116:119], v4, s[36:39], 0 offen offset:16
    buffer_load_dwordx4 v[120:123], v4, s[36:39], 0 offen offset:32
    buffer_load_dwordx4 v[124:127], v4, s[36:39], s70 offen offset:0
    buffer_load_dwordx4 v[128:131], v4, s[36:39], s70 offen offset:16
    buffer_load_dwordx4 v[132:135], v4, s[36:39], s70 offen offset:32
    buffer_load_dword v12, v12, s[52:55], 0 offen sc1
    buffer_load_ushort v13, v6, s[44:47], 0 offen offset:0
    buffer_load_ushort v14, v6, s[44:47], 0 offen offset:256
    buffer_load_ushort v15, v6, s[44:47], 0 offen offset:512
    v_pk_mul_f32 v[216:217], v[216:217], v[184:185]
    v_pk_mul_f32 v[218:219], v[218:219], v[186:187]
    v_pk_mul_f32 v[220:221], v[220:221], v[188:189]
    v_pk_mul_f32 v[222:223], v[222:223], v[190:191]
    v_pk_mul_f32 v[224:225], v[224:225], v[192:193]
    v_pk_mul_f32 v[226:227], v[226:227], v[194:195]
    v_pk_mul_f32 v[228:229], v[228:229], v[196:197]
    v_pk_mul_f32 v[230:231], v[230:231], v[198:199]
    v_mfma_f32_32x32x16_bf16 v[200:215], v[64:67], v[136:139], 0
    v_exp_f32 v216, v216
    v_exp_f32 v217, v217
    v_exp_f32 v218, v218
    v_exp_f32 v219, v219
    v_mfma_f32_32x32x16_bf16 v[200:215], v[68:71], v[140:143], v[200:215]
    v_exp_f32 v220, v220
    v_exp_f32 v221, v221
    v_exp_f32 v222, v222
    v_exp_f32 v223, v223
    v_mfma_f32_32x32x16_bf16 v[200:215], v[72:75], v[144:147], v[200:215]
    v_exp_f32 v224, v224
    v_exp_f32 v225, v225
    v_exp_f32 v226, v226
    v_exp_f32 v227, v227
    v_mfma_f32_32x32x16_bf16 v[200:215], v[76:79], v[148:151], v[200:215]
    v_exp_f32 v228, v228
    v_exp_f32 v229, v229
    v_exp_f32 v230, v230
    v_exp_f32 v231, v231
    v_pk_add_f32 v[216:217], v[216:217], 1.0 op_sel_hi:[1,0]
    v_pk_add_f32 v[218:219], v[218:219], 1.0 op_sel_hi:[1,0]
    v_pk_add_f32 v[220:221], v[220:221], 1.0 op_sel_hi:[1,0]
    v_pk_add_f32 v[222:223], v[222:223], 1.0 op_sel_hi:[1,0]
    v_pk_add_f32 v[224:225], v[224:225], 1.0 op_sel_hi:[1,0]
    v_pk_add_f32 v[226:227], v[226:227], 1.0 op_sel_hi:[1,0]
    v_pk_add_f32 v[228:229], v[228:229], 1.0 op_sel_hi:[1,0]
    v_pk_add_f32 v[230:231], v[230:231], 1.0 op_sel_hi:[1,0]
    v_mfma_f32_32x32x16_bf16 v[200:215], v[80:83], v[152:155], v[200:215]
    v_rcp_f32 v216, v216
    v_rcp_f32 v217, v217
    v_rcp_f32 v218, v218
    v_rcp_f32 v219, v219
    v_mfma_f32_32x32x16_bf16 v[200:215], v[84:87], v[156:159], v[200:215]
    v_rcp_f32 v220, v220
    v_rcp_f32 v221, v221
    v_rcp_f32 v222, v222
    v_rcp_f32 v223, v223
    v_mfma_f32_32x32x16_bf16 v[32:47], v[96:99], v[144:147], v[32:47]
    v_rcp_f32 v224, v224
    v_rcp_f32 v225, v225
    v_rcp_f32 v226, v226
    v_rcp_f32 v227, v227
    v_mfma_f32_32x32x16_bf16 v[32:47], v[100:103], v[148:151], v[32:47]
    v_rcp_f32 v228, v228
    v_rcp_f32 v229, v229
    v_rcp_f32 v230, v230
    v_rcp_f32 v231, v231
    v_pk_mul_f32 v[216:217], v[216:217], v[184:185]
    v_pk_mul_f32 v[218:219], v[218:219], v[186:187]
    v_pk_mul_f32 v[220:221], v[220:221], v[188:189]
    v_pk_mul_f32 v[222:223], v[222:223], v[190:191]
    v_pk_mul_f32 v[224:225], v[224:225], v[192:193]
    v_pk_mul_f32 v[226:227], v[226:227], v[194:195]
    v_pk_mul_f32 v[228:229], v[228:229], v[196:197]
    v_pk_mul_f32 v[230:231], v[230:231], v[198:199]
    v_pk_fma_f32 v[240:241], v[216:217], v[216:217], v[240:241]
    v_cvt_pk_bf16_f32 v232, v216, v217
    v_pk_fma_f32 v[216:217], v[200:201], v[200:201], s[68:69]
    v_pk_fma_f32 v[242:243], v[218:219], v[218:219], v[242:243]
    v_cvt_pk_bf16_f32 v233, v218, v219
    v_pk_fma_f32 v[218:219], v[202:203], v[202:203], s[68:69]
    ds_write_b64 v9, v[232:233] offset:128
    v_pk_fma_f32 v[240:241], v[220:221], v[220:221], v[240:241]
    v_cvt_pk_bf16_f32 v234, v220, v221
    v_pk_fma_f32 v[220:221], v[204:205], v[204:205], s[68:69]
    v_pk_fma_f32 v[242:243], v[222:223], v[222:223], v[242:243]
    v_cvt_pk_bf16_f32 v235, v222, v223
    v_pk_fma_f32 v[222:223], v[206:207], v[206:207], s[68:69]
    ds_write_b64 v9, v[234:235] offset:144
    v_pk_fma_f32 v[240:241], v[224:225], v[224:225], v[240:241]
    v_cvt_pk_bf16_f32 v236, v224, v225
    v_pk_fma_f32 v[224:225], v[208:209], v[208:209], s[68:69]
    v_pk_fma_f32 v[242:243], v[226:227], v[226:227], v[242:243]
    v_cvt_pk_bf16_f32 v237, v226, v227
    v_pk_fma_f32 v[226:227], v[210:211], v[210:211], s[68:69]
    ds_write_b64 v9, v[236:237] offset:160
    v_pk_fma_f32 v[240:241], v[228:229], v[228:229], v[240:241]
    v_cvt_pk_bf16_f32 v238, v228, v229
    v_pk_fma_f32 v[228:229], v[212:213], v[212:213], s[68:69]
    v_pk_fma_f32 v[242:243], v[230:231], v[230:231], v[242:243]
    v_cvt_pk_bf16_f32 v239, v230, v231
    v_pk_fma_f32 v[230:231], v[214:215], v[214:215], s[68:69]
    ds_write_b64 v9, v[238:239] offset:176
    v_pk_mul_f32 v[216:217], v[216:217], v[200:201]
    v_pk_mul_f32 v[218:219], v[218:219], v[202:203]
    v_pk_mul_f32 v[220:221], v[220:221], v[204:205]
    v_pk_mul_f32 v[222:223], v[222:223], v[206:207]
    v_pk_mul_f32 v[224:225], v[224:225], v[208:209]
    v_pk_mul_f32 v[226:227], v[226:227], v[210:211]
    v_pk_mul_f32 v[228:229], v[228:229], v[212:213]
    v_pk_mul_f32 v[230:231], v[230:231], v[214:215]
    v_mfma_f32_32x32x16_bf16 v[184:199], v[64:67], v[160:163], 0
    v_exp_f32 v216, v216
    v_exp_f32 v217, v217
    v_exp_f32 v218, v218
    v_exp_f32 v219, v219
    v_mfma_f32_32x32x16_bf16 v[184:199], v[68:71], v[164:167], v[184:199]
    v_exp_f32 v220, v220
    v_exp_f32 v221, v221
    v_exp_f32 v222, v222
    v_exp_f32 v223, v223
    v_mfma_f32_32x32x16_bf16 v[184:199], v[72:75], v[168:171], v[184:199]
    v_exp_f32 v224, v224
    v_exp_f32 v225, v225
    v_exp_f32 v226, v226
    v_exp_f32 v227, v227
    v_mfma_f32_32x32x16_bf16 v[184:199], v[76:79], v[172:175], v[184:199]
    v_exp_f32 v228, v228
    v_exp_f32 v229, v229
    v_exp_f32 v230, v230
    v_exp_f32 v231, v231
    v_pk_add_f32 v[216:217], v[216:217], 1.0 op_sel_hi:[1,0]
    v_pk_add_f32 v[218:219], v[218:219], 1.0 op_sel_hi:[1,0]
    v_pk_add_f32 v[220:221], v[220:221], 1.0 op_sel_hi:[1,0]
    v_pk_add_f32 v[222:223], v[222:223], 1.0 op_sel_hi:[1,0]
    v_pk_add_f32 v[224:225], v[224:225], 1.0 op_sel_hi:[1,0]
    v_pk_add_f32 v[226:227], v[226:227], 1.0 op_sel_hi:[1,0]
    v_pk_add_f32 v[228:229], v[228:229], 1.0 op_sel_hi:[1,0]
    v_pk_add_f32 v[230:231], v[230:231], 1.0 op_sel_hi:[1,0]
    v_mfma_f32_32x32x16_bf16 v[184:199], v[80:83], v[176:179], v[184:199]
    v_rcp_f32 v216, v216
    v_rcp_f32 v217, v217
    v_rcp_f32 v218, v218
    v_rcp_f32 v219, v219
    v_mfma_f32_32x32x16_bf16 v[184:199], v[84:87], v[180:183], v[184:199]
    v_rcp_f32 v220, v220
    v_rcp_f32 v221, v221
    v_rcp_f32 v222, v222
    v_rcp_f32 v223, v223
    v_mfma_f32_32x32x16_bf16 v[32:47], v[104:107], v[152:155], v[32:47]
    v_rcp_f32 v224, v224
    v_rcp_f32 v225, v225
    v_rcp_f32 v226, v226
    v_rcp_f32 v227, v227
    v_mfma_f32_32x32x16_bf16 v[32:47], v[108:111], v[156:159], v[32:47]
    v_rcp_f32 v228, v228
    v_rcp_f32 v229, v229
    v_rcp_f32 v230, v230
    v_rcp_f32 v231, v231
    v_pk_mul_f32 v[216:217], v[216:217], v[200:201]
    v_pk_mul_f32 v[218:219], v[218:219], v[202:203]
    v_pk_mul_f32 v[220:221], v[220:221], v[204:205]
    v_pk_mul_f32 v[222:223], v[222:223], v[206:207]
    v_pk_mul_f32 v[224:225], v[224:225], v[208:209]
    v_pk_mul_f32 v[226:227], v[226:227], v[210:211]
    v_pk_mul_f32 v[228:229], v[228:229], v[212:213]
    v_pk_mul_f32 v[230:231], v[230:231], v[214:215]
    v_pk_fma_f32 v[244:245], v[216:217], v[216:217], v[244:245]
    v_cvt_pk_bf16_f32 v232, v216, v217
    v_pk_fma_f32 v[216:217], v[184:185], v[184:185], s[68:69]
    v_pk_fma_f32 v[246:247], v[218:219], v[218:219], v[246:247]
    v_cvt_pk_bf16_f32 v233, v218, v219
    v_pk_fma_f32 v[218:219], v[186:187], v[186:187], s[68:69]
    ds_write_b64 v9, v[232:233] offset:13184
    v_pk_fma_f32 v[244:245], v[220:221], v[220:221], v[244:245]
    v_cvt_pk_bf16_f32 v234, v220, v221
    v_pk_fma_f32 v[220:221], v[188:189], v[188:189], s[68:69]
    v_pk_fma_f32 v[246:247], v[222:223], v[222:223], v[246:247]
    v_cvt_pk_bf16_f32 v235, v222, v223
    v_pk_fma_f32 v[222:223], v[190:191], v[190:191], s[68:69]
    ds_write_b64 v9, v[234:235] offset:13200
    v_pk_fma_f32 v[244:245], v[224:225], v[224:225], v[244:245]
    v_cvt_pk_bf16_f32 v236, v224, v225
    v_pk_fma_f32 v[224:225], v[192:193], v[192:193], s[68:69]
    v_pk_fma_f32 v[246:247], v[226:227], v[226:227], v[246:247]
    v_cvt_pk_bf16_f32 v237, v226, v227
    v_pk_fma_f32 v[226:227], v[194:195], v[194:195], s[68:69]
    ds_write_b64 v9, v[236:237] offset:13216
    v_pk_fma_f32 v[244:245], v[228:229], v[228:229], v[244:245]
    v_cvt_pk_bf16_f32 v238, v228, v229
    v_pk_fma_f32 v[228:229], v[196:197], v[196:197], s[68:69]
    v_pk_fma_f32 v[246:247], v[230:231], v[230:231], v[246:247]
    v_cvt_pk_bf16_f32 v239, v230, v231
    v_pk_fma_f32 v[230:231], v[198:199], v[198:199], s[68:69]
    ds_write_b64 v9, v[238:239] offset:13232
    buffer_load_dwordx4 v[64:67], v4, s[36:39], s71 offen offset:0
    buffer_load_dwordx4 v[68:71], v4, s[36:39], s71 offen offset:16
    buffer_load_dwordx4 v[72:75], v4, s[36:39], s71 offen offset:32
    buffer_load_dword v76, v8, s[40:43], 0 offen offset:0
    buffer_load_dword v77, v8, s[40:43], 0 offen offset:256
    buffer_load_dword v78, v8, s[40:43], 0 offen offset:512
    v_pk_mul_f32 v[216:217], v[216:217], v[184:185]
    v_pk_mul_f32 v[218:219], v[218:219], v[186:187]
    v_pk_mul_f32 v[220:221], v[220:221], v[188:189]
    v_pk_mul_f32 v[222:223], v[222:223], v[190:191]
    v_pk_mul_f32 v[224:225], v[224:225], v[192:193]
    v_pk_mul_f32 v[226:227], v[226:227], v[194:195]
    v_pk_mul_f32 v[228:229], v[228:229], v[196:197]
    v_pk_mul_f32 v[230:231], v[230:231], v[198:199]
    v_mfma_f32_32x32x16_bf16 v[48:63], v[88:91], v[160:163], 0
    v_exp_f32 v216, v216
    v_exp_f32 v217, v217
    v_exp_f32 v218, v218
    v_exp_f32 v219, v219
    v_mfma_f32_32x32x16_bf16 v[48:63], v[92:95], v[164:167], v[48:63]
    v_exp_f32 v220, v220
    v_exp_f32 v221, v221
    v_exp_f32 v222, v222
    v_exp_f32 v223, v223
    v_mfma_f32_32x32x16_bf16 v[48:63], v[96:99], v[168:171], v[48:63]
    v_exp_f32 v224, v224
    v_exp_f32 v225, v225
    v_exp_f32 v226, v226
    v_exp_f32 v227, v227
    v_mfma_f32_32x32x16_bf16 v[48:63], v[100:103], v[172:175], v[48:63]
    v_exp_f32 v228, v228
    v_exp_f32 v229, v229
    v_exp_f32 v230, v230
    v_exp_f32 v231, v231
    v_pk_add_f32 v[216:217], v[216:217], 1.0 op_sel_hi:[1,0]
    v_pk_add_f32 v[218:219], v[218:219], 1.0 op_sel_hi:[1,0]
    v_pk_add_f32 v[220:221], v[220:221], 1.0 op_sel_hi:[1,0]
    v_pk_add_f32 v[222:223], v[222:223], 1.0 op_sel_hi:[1,0]
    v_pk_add_f32 v[224:225], v[224:225], 1.0 op_sel_hi:[1,0]
    v_pk_add_f32 v[226:227], v[226:227], 1.0 op_sel_hi:[1,0]
    v_pk_add_f32 v[228:229], v[228:229], 1.0 op_sel_hi:[1,0]
    v_pk_add_f32 v[230:231], v[230:231], 1.0 op_sel_hi:[1,0]
    v_mfma_f32_32x32x16_bf16 v[48:63], v[104:107], v[176:179], v[48:63]
    v_rcp_f32 v216, v216
    v_rcp_f32 v217, v217
    v_rcp_f32 v218, v218
    v_rcp_f32 v219, v219
    v_mfma_f32_32x32x16_bf16 v[48:63], v[108:111], v[180:183], v[48:63]
    v_rcp_f32 v220, v220
    v_rcp_f32 v221, v221
    v_rcp_f32 v222, v222
    v_rcp_f32 v223, v223
    v_rcp_f32 v224, v224
    v_rcp_f32 v225, v225
    v_rcp_f32 v226, v226
    v_rcp_f32 v227, v227
    v_rcp_f32 v228, v228
    v_rcp_f32 v229, v229
    v_rcp_f32 v230, v230
    v_rcp_f32 v231, v231
    v_pk_mul_f32 v[216:217], v[216:217], v[184:185]
    v_pk_mul_f32 v[218:219], v[218:219], v[186:187]
    v_pk_mul_f32 v[220:221], v[220:221], v[188:189]
    v_pk_mul_f32 v[222:223], v[222:223], v[190:191]
    v_pk_mul_f32 v[224:225], v[224:225], v[192:193]
    v_pk_mul_f32 v[226:227], v[226:227], v[194:195]
    v_pk_mul_f32 v[228:229], v[228:229], v[196:197]
    v_pk_mul_f32 v[230:231], v[230:231], v[198:199]
    v_pk_fma_f32 v[248:249], v[216:217], v[216:217], v[248:249]
    v_cvt_pk_bf16_f32 v232, v216, v217
    v_pk_fma_f32 v[250:251], v[218:219], v[218:219], v[250:251]
    v_cvt_pk_bf16_f32 v233, v218, v219
    ds_write_b64 v9, v[232:233] offset:26240
    v_pk_fma_f32 v[248:249], v[220:221], v[220:221], v[248:249]
    v_cvt_pk_bf16_f32 v234, v220, v221
    v_pk_fma_f32 v[250:251], v[222:223], v[222:223], v[250:251]
    v_cvt_pk_bf16_f32 v235, v222, v223
    ds_write_b64 v9, v[234:235] offset:26256
    v_pk_fma_f32 v[248:249], v[224:225], v[224:225], v[248:249]
    v_cvt_pk_bf16_f32 v236, v224, v225
    v_pk_fma_f32 v[250:251], v[226:227], v[226:227], v[250:251]
    v_cvt_pk_bf16_f32 v237, v226, v227
    ds_write_b64 v9, v[236:237] offset:26272
    v_pk_fma_f32 v[248:249], v[228:229], v[228:229], v[248:249]
    v_cvt_pk_bf16_f32 v238, v228, v229
    v_pk_fma_f32 v[250:251], v[230:231], v[230:231], v[250:251]
    v_cvt_pk_bf16_f32 v239, v230, v231
    ds_write_b64 v9, v[238:239] offset:26288
    s_cmp_lg_u32 s63, 0
    s_cbranch_scc1 L_notail
    s_mov_b32 exec_hi, 0
    v_pk_fma_f32 v[216:217], v[16:17], v[16:17], s[68:69]
    v_pk_fma_f32 v[218:219], v[18:19], v[18:19], s[68:69]
    v_pk_fma_f32 v[220:221], v[32:33], v[32:33], s[68:69]
    v_pk_fma_f32 v[222:223], v[34:35], v[34:35], s[68:69]
    v_pk_fma_f32 v[224:225], v[48:49], v[48:49], s[68:69]
    v_pk_fma_f32 v[226:227], v[50:51], v[50:51], s[68:69]
    v_pk_mul_f32 v[216:217], v[216:217], v[16:17]
    v_pk_mul_f32 v[218:219], v[218:219], v[18:19]
    v_pk_mul_f32 v[220:221], v[220:221], v[32:33]
    v_pk_mul_f32 v[222:223], v[222:223], v[34:35]
    v_pk_mul_f32 v[224:225], v[224:225], v[48:49]
    v_pk_mul_f32 v[226:227], v[226:227], v[50:51]
    v_exp_f32 v216, v216
    v_exp_f32 v217, v217
    v_exp_f32 v218, v218
    v_exp_f32 v219, v219
    v_exp_f32 v220, v220
    v_exp_f32 v221, v221
    v_exp_f32 v222, v222
    v_exp_f32 v223, v223
    v_exp_f32 v224, v224
    v_exp_f32 v225, v225
    v_exp_f32 v226, v226
    v_exp_f32 v227, v227
    v_pk_add_f32 v[216:217], v[216:217], 1.0 op_sel_hi:[1,0]
    v_pk_add_f32 v[218:219], v[218:219], 1.0 op_sel_hi:[1,0]
    v_pk_add_f32 v[220:221], v[220:221], 1.0 op_sel_hi:[1,0]
    v_pk_add_f32 v[222:223], v[222:223], 1.0 op_sel_hi:[1,0]
    v_pk_add_f32 v[224:225], v[224:225], 1.0 op_sel_hi:[1,0]
    v_pk_add_f32 v[226:227], v[226:227], 1.0 op_sel_hi:[1,0]
    v_rcp_f32 v216, v216
    v_rcp_f32 v217, v217
    v_rcp_f32 v218, v218
    v_rcp_f32 v219, v219
    v_rcp_f32 v220, v220
    v_rcp_f32 v221, v221
    v_rcp_f32 v222, v222
    v_rcp_f32 v223, v223
    v_rcp_f32 v224, v224
    v_rcp_f32 v225, v225
    v_rcp_f32 v226, v226
    v_rcp_f32 v227, v227
    v_pk_mul_f32 v[216:217], v[216:217], v[16:17]
    v_pk_mul_f32 v[218:219], v[218:219], v[18:19]
    v_pk_mul_f32 v[220:221], v[220:221], v[32:33]
    v_pk_mul_f32 v[222:223], v[222:223], v[34:35]
    v_pk_mul_f32 v[224:225], v[224:225], v[48:49]
    v_pk_mul_f32 v[226:227], v[226:227], v[50:51]
    v_pk_fma_f32 v[240:241], v[216:217], v[216:217], v[240:241]
    v_cvt_pk_bf16_f32 v232, v216, v217
    v_pk_fma_f32 v[242:243], v[218:219], v[218:219], v[242:243]
    v_cvt_pk_bf16_f32 v233, v218, v219
    ds_write_b64 v9, v[232:233] offset:384
    v_pk_fma_f32 v[244:245], v[220:221], v[220:221], v[244:245]
    v_cvt_pk_bf16_f32 v234, v220, v221
    v_pk_fma_f32 v[246:247], v[222:223], v[222:223], v[246:247]
    v_cvt_pk_bf16_f32 v235, v222, v223
    ds_write_b64 v9, v[234:235] offset:13440
    v_pk_fma_f32 v[248:249], v[224:225], v[224:225], v[248:249]
    v_cvt_pk_bf16_f32 v236, v224, v225
    v_pk_fma_f32 v[250:251], v[226:227], v[226:227], v[250:251]
    v_cvt_pk_bf16_f32 v237, v226, v227
    ds_write_b64 v9, v[236:237] offset:26496
    s_mov_b32 exec_hi, -1
L_notail:
    v_pk_add_f32 v[240:241], v[240:241], v[242:243]
    v_pk_add_f32 v[244:245], v[244:245], v[246:247]
    v_pk_add_f32 v[248:249], v[248:249], v[250:251]
    v_add_f32 v240, v240, v241
    ds_write_b32 v11, v240 offset:0
    v_add_f32 v244, v244, v245
    ds_write_b32 v11, v244 offset:128
    v_add_f32 v248, v248, v249
    ds_write_b32 v11, v248 offset:256
    s_waitcnt lgkmcnt(0)
    s_barrier
    s_waitcnt vmcnt(0)
    s_cmp_lg_u32 s63, 0
    s_cbranch_scc1 L_nopub
    s_mov_b32 s75, 0x20000
L_rpa:
    v_readfirstlane_b32 s74, v12
    s_nop 1
    s_cmp_ge_u32 s74, 96
    s_cbranch_scc1 L_rda
    s_sub_u32 s75, s75, 1
    s_cbranch_scc1 L_rda
    v_mov_b32 v12, 0
    buffer_load_dword v12, v12, s[52:55], 0 offen sc1
    s_waitcnt vmcnt(0)
    s_branch L_rpa
L_rda:
    s_cmp_ge_u32 s60, 2
    s_cbranch_scc1 L_nopub
    v_lshlrev_b32 v2, 4, v0
    v_add_u32 v2, 156672, v2
    ds_read_b128 v[232:235], v2 offset:0
    ds_read_b128 v[236:239], v2 offset:1536
    ds_read_b128 v[240:243], v2 offset:3072
    ds_read_b128 v[244:247], v2 offset:4608
    s_lshl_b32 s70, s2, 6
    v_lshrrev_b32 v2, 2, v0
    v_lshl_add_u32 v2, v2, 14, s70
    v_and_b32 v3, 3, v0
    v_lshl_add_u32 v2, v3, 4, v2
    v_mov_b32 v3, 0x7fffff00
    v_cmp_gt_u32 vcc, 96, v0
    s_nop 1
    v_cndmask_b32 v2, v3, v2, vcc
    s_waitcnt lgkmcnt(0)
    v_pk_add_f32 v[232:233], v[232:233], v[236:237]
    v_pk_add_f32 v[240:241], v[240:241], v[244:245]
    v_pk_add_f32 v[234:235], v[234:235], v[238:239]
    v_pk_add_f32 v[242:243], v[242:243], v[246:247]
    v_pk_add_f32 v[232:233], v[232:233], v[240:241]
    v_pk_add_f32 v[234:235], v[234:235], v[242:243]
    v_and_b32 v232, 0x7fffffff, v232
    v_and_b32 v233, 0x7fffffff, v233
    v_and_b32 v234, 0x7fffffff, v234
    v_and_b32 v235, 0x7fffffff, v235
    buffer_store_dwordx4 v[232:235], v2, s[56:59], 0 offen sc1
    s_nop 1
L_nopub:
    s_cmp_eq_u32 s60, 2
    s_cselect_b32 s74, s2, 96
    v_lshlrev_b32 v160, 16, v112
    v_and_b32 v161, s66, v112
    v_lshlrev_b32 v162, 16, v113
    v_and_b32 v163, s66, v113
    v_lshlrev_b32 v164, 16, v114
    v_and_b32 v165, s66, v114
    v_lshlrev_b32 v166, 16, v115
    v_and_b32 v167, s66, v115
    v_lshlrev_b32 v168, 16, v116
    v_and_b32 v169, s66, v116
    v_lshlrev_b32 v170, 16, v117
    v_and_b32 v171, s66, v117
    v_lshlrev_b32 v172, 16, v118
    v_and_b32 v173, s66, v118
    v_lshlrev_b32 v174, 16, v119
    v_and_b32 v175, s66, v119
    v_lshlrev_b32 v176, 16, v120
    v_and_b32 v177, s66, v120
    v_lshlrev_b32 v178, 16, v121
    v_and_b32 v179, s66, v121
    v_lshlrev_b32 v180, 16, v122
    v_and_b32 v181, s66, v122
    v_lshlrev_b32 v182, 16, v123
    v_and_b32 v183, s66, v123
    v_lshlrev_b32 v184, 16, v124
    v_and_b32 v185, s66, v124
    v_lshlrev_b32 v186, 16, v125
    v_and_b32 v187, s66, v125
    v_lshlrev_b32 v188, 16, v126
    v_and_b32 v189, s66, v126
    v_lshlrev_b32 v190, 16, v127
    v_and_b32 v191, s66, v127
    v_lshlrev_b32 v192, 16, v128
    v_and_b32 v193, s66, v128
    v_lshlrev_b32 v194, 16, v129
    v_and_b32 v195, s66, v129
    v_lshlrev_b32 v196, 16, v130
    v_and_b32 v197, s66, v130
    v_lshlrev_b32 v198, 16, v131
    v_and_b32 v199, s66, v131
    v_lshlrev_b32 v200, 16, v132
    v_and_b32 v201, s66, v132
    v_lshlrev_b32 v202, 16, v133
    v_and_b32 v203, s66, v133
    v_lshlrev_b32 v204, 16, v134
    v_and_b32 v205, s66, v134
    v_lshlrev_b32 v206, 16, v135
    v_and_b32 v207, s66, v135
    v_lshlrev_b32 v208, 16, v64
    v_and_b32 v209, s66, v64
    v_lshlrev_b32 v210, 16, v65
    v_and_b32 v211, s66, v65
    v_lshlrev_b32 v212, 16, v66
    v_and_b32 v213, s66, v66
    v_lshlrev_b32 v214, 16, v67
    v_and_b32 v215, s66, v67
    v_lshlrev_b32 v216, 16, v68
    v_and_b32 v217, s66, v68
    v_lshlrev_b32 v218, 16, v69
    v_and_b32 v219, s66, v69
    v_lshlrev_b32 v220, 16, v70
    v_and_b32 v221, s66, v70
    v_lshlrev_b32 v222, 16, v71
    v_and_b32 v223, s66, v71
    v_lshlrev_b32 v224, 16, v72
    v_and_b32 v225, s66, v72
    v_lshlrev_b32 v226, 16, v73
    v_and_b32 v227, s66, v73
    v_lshlrev_b32 v228, 16, v74
    v_and_b32 v229, s66, v74
    v_lshlrev_b32 v230, 16, v75
    v_and_b32 v231, s66, v75
    v_mov_b32 v11, v10
    v_mov_b32 v8, v76
    v_mov_b32 v9, v77
    v_mov_b32 v10, v78
    s_lshr_b32 s70, s2, 3
    s_and_b32 s70, s70, 15
    s_mul_i32 s70, s70, 4352
    s_add_u32 s70, s70, 2097152
    v_lshl_add_u32 v12, v1, 3, s70
    s_cmp_ge_u32 s74, 24
    s_cbranch_scc1 L_nored
    s_setprio 2
    v_lshlrev_b32 v2, 4, v1
    s_mov_b32 s75, 0x20000
    s_lshl_b32 s76, s2, 14
    s_add_u32 s77, s76, 4096
    s_add_u32 s78, s77, 4096
    s_add_u32 s79, s78, 4096
    buffer_load_dwordx4 v[16:19], v2, s[56:59], s76 offen offset:0 sc1
    buffer_load_dwordx4 v[20:23], v2, s[56:59], s76 offen offset:1024 sc1
    buffer_load_dwordx4 v[24:27], v2, s[56:59], s76 offen offset:2048 sc1
    buffer_load_dwordx4 v[28:31], v2, s[56:59], s76 offen offset:3072 sc1
    buffer_load_dwordx4 v[32:35], v2, s[56:59], s77 offen offset:0 sc1
    buffer_load_dwordx4 v[36:39], v2, s[56:59], s77 offen offset:1024 sc1
    buffer_load_dwordx4 v[40:43], v2, s[56:59], s77 offen offset:2048 sc1
    buffer_load_dwordx4 v[44:47], v2, s[56:59], s77 offen offset:3072 sc1
    buffer_load_dwordx4 v[48:51], v2, s[56:59], s78 offen offset:0 sc1
    buffer_load_dwordx4 v[52:55], v2, s[56:59], s78 offen offset:1024 sc1
    buffer_load_dwordx4 v[56:59], v2, s[56:59], s78 offen offset:2048 sc1
    buffer_load_dwordx4 v[60:63], v2, s[56:59], s78 offen offset:3072 sc1
    buffer_load_dwordx4 v[64:67], v2, s[56:59], s79 offen offset:0 sc1
    buffer_load_dwordx4 v[68:71], v2, s[56:59], s79 offen offset:1024 sc1
    buffer_load_dwordx4 v[72:75], v2, s[56:59], s79 offen offset:2048 sc1
    buffer_load_dwordx4 v[76:79], v2, s[56:59], s79 offen offset:3072 sc1
L_redpoll:
    s_waitcnt vmcnt(0)
    v_or3_b32 v3, v16, v17, v18
    v_or3_b32 v3, v3, v19, v20
    v_or3_b32 v3, v3, v21, v22
    v_or3_b32 v3, v3, v23, v24
    v_or3_b32 v3, v3, v25, v26
    v_or3_b32 v3, v3, v27, v28
    v_or3_b32 v3, v3, v29, v30
    v_or3_b32 v3, v3, v31, v32
    v_or3_b32 v3, v3, v33, v34
    v_or3_b32 v3, v3, v35, v36
    v_or3_b32 v3, v3, v37, v38
    v_or3_b32 v3, v3, v39, v40
    v_or3_b32 v3, v3, v41, v42
    v_or3_b32 v3, v3, v43, v44
    v_or3_b32 v3, v3, v45, v46
    v_or3_b32 v3, v3, v47, v48
    v_or3_b32 v3, v3, v49, v50
    v_or3_b32 v3, v3, v51, v52
    v_or3_b32 v3, v3, v53, v54
    v_or3_b32 v3, v3, v55, v56
    v_or3_b32 v3, v3, v57, v58
    v_or3_b32 v3, v3, v59, v60
    v_or3_b32 v3, v3, v61, v62
    v_or3_b32 v3, v3, v63, v64
    v_or3_b32 v3, v3, v65, v66
    v_or3_b32 v3, v3, v67, v68
    v_or3_b32 v3, v3, v69, v70
    v_or3_b32 v3, v3, v71, v72
    v_or3_b32 v3, v3, v73, v74
    v_or3_b32 v3, v3, v75, v76
    v_or3_b32 v3, v3, v77, v78
    v_or_b32 v3, v3, v79
    v_cmp_gt_i32 vcc, 0, v3
    s_cbranch_vccz L_redok1
    buffer_load_dwordx4 v[16:19], v2, s[56:59], s76 offen offset:0 sc1
    buffer_load_dwordx4 v[20:23], v2, s[56:59], s76 offen offset:1024 sc1
    buffer_load_dwordx4 v[24:27], v2, s[56:59], s76 offen offset:2048 sc1
    buffer_load_dwordx4 v[28:31], v2, s[56:59], s76 offen offset:3072 sc1
    buffer_load_dwordx4 v[32:35], v2, s[56:59], s77 offen offset:0 sc1
    buffer_load_dwordx4 v[36:39], v2, s[56:59], s77 offen offset:1024 sc1
    buffer_load_dwordx4 v[40:43], v2, s[56:59], s77 offen offset:2048 sc1
    buffer_load_dwordx4 v[44:47], v2, s[56:59], s77 offen offset:3072 sc1
    buffer_load_dwordx4 v[48:51], v2, s[56:59], s78 offen offset:0 sc1
    buffer_load_dwordx4 v[52:55], v2, s[56:59], s78 offen offset:1024 sc1
    buffer_load_dwordx4 v[56:59], v2, s[56:59], s78 offen offset:2048 sc1
    buffer_load_dwordx4 v[60:63], v2, s[56:59], s78 offen offset:3072 sc1
    buffer_load_dwordx4 v[64:67], v2, s[56:59], s79 offen offset:0 sc1
    buffer_load_dwordx4 v[68:71], v2, s[56:59], s79 offen offset:1024 sc1
    buffer_load_dwordx4 v[72:75], v2, s[56:59], s79 offen offset:2048 sc1
    buffer_load_dwordx4 v[76:79], v2, s[56:59], s79 offen offset:3072 sc1
    s_sub_u32 s75, s75, 1
    s_cbranch_scc0 L_redpoll
L_redok1:
    v_pk_add_f32 v[16:17], v[16:17], v[48:49]
    v_pk_add_f32 v[18:19], v[18:19], v[50:51]
    v_pk_add_f32 v[20:21], v[20:21], v[52:53]
    v_pk_add_f32 v[22:23], v[22:23], v[54:55]
    v_pk_add_f32 v[24:25], v[24:25], v[56:57]
    v_pk_add_f32 v[26:27], v[26:27], v[58:59]
    v_pk_add_f32 v[28:29], v[28:29], v[60:61]
    v_pk_add_f32 v[30:31], v[30:31], v[62:63]
    v_pk_add_f32 v[32:33], v[32:33], v[64:65]
    v_pk_add_f32 v[34:35], v[34:35], v[66:67]
    v_pk_add_f32 v[36:37], v[36:37], v[68:69]
    v_pk_add_f32 v[38:39], v[38:39], v[70:71]
    v_pk_add_f32 v[40:41], v[40:41], v[72:73]
    v_pk_add_f32 v[42:43], v[42:43], v[74:75]
    v_pk_add_f32 v[44:45], v[44:45], v[76:77]
    v_pk_add_f32 v[46:47], v[46:47], v[78:79]
    v_pk_add_f32 v[16:17], v[16:17], v[32:33]
    v_pk_add_f32 v[18:19], v[18:19], v[34:35]
    v_pk_add_f32 v[20:21], v[20:21], v[36:37]
    v_pk_add_f32 v[22:23], v[22:23], v[38:39]
    v_pk_add_f32 v[24:25], v[24:25], v[40:41]
    v_pk_add_f32 v[26:27], v[26:27], v[42:43]
    v_pk_add_f32 v[28:29], v[28:29], v[44:45]
    v_pk_add_f32 v[30:31], v[30:31], v[46:47]
    v_pk_add_f32 v[16:17], v[16:17], v[24:25]
    v_pk_add_f32 v[18:19], v[18:19], v[26:27]
    v_pk_add_f32 v[20:21], v[20:21], v[28:29]
    v_pk_add_f32 v[22:23], v[22:23], v[30:31]
    v_pk_add_f32 v[144:145], v[16:17], v[20:21]
    v_pk_add_f32 v[146:147], v[18:19], v[22:23]
L_redjoin:
    s_lshl_b32 s70, s2, 6
    s_add_u32 s70, s70, 2097152
    v_lshrrev_b32 v2, 2, v1
    v_mul_u32_u24 v2, 4352, v2
    v_and_b32 v3, 3, v1
    v_lshl_add_u32 v2, v3, 4, v2
    v_add_f32_dpp v144, v144, v144 row_ror:4 row_mask:0xf bank_mask:0xf
    v_add_f32_dpp v145, v145, v145 row_ror:4 row_mask:0xf bank_mask:0xf
    v_add_f32_dpp v146, v146, v146 row_ror:4 row_mask:0xf bank_mask:0xf
    v_add_f32_dpp v147, v147, v147 row_ror:4 row_mask:0xf bank_mask:0xf
    v_add_f32_dpp v144, v144, v144 row_ror:8 row_mask:0xf bank_mask:0xf
    v_add_f32_dpp v145, v145, v145 row_ror:8 row_mask:0xf bank_mask:0xf
    v_add_f32_dpp v146, v146, v146 row_ror:8 row_mask:0xf bank_mask:0xf
    v_add_f32_dpp v147, v147, v147 row_ror:8 row_mask:0xf bank_mask:0xf
    v_mov_b32 v148, v144
    v_mov_b32 v149, v145
    v_mov_b32 v150, v146
    v_mov_b32 v151, v147
    v_permlane16_swap_b32 v144, v148
    v_permlane16_swap_b32 v145, v149
    v_permlane16_swap_b32 v146, v150
    v_permlane16_swap_b32 v147, v151
    v_add_f32 v144, v144, v148
    v_add_f32 v145, v145, v149
    v_add_f32 v146, v146, v150
    v_add_f32 v147, v147, v151
    v_mov_b32 v148, v144
    v_mov_b32 v149, v145
    v_mov_b32 v150, v146
    v_mov_b32 v151, v147
    v_permlane32_swap_b32 v144, v148
    v_permlane32_swap_b32 v145, v149
    v_permlane32_swap_b32 v146, v150
    v_permlane32_swap_b32 v147, v151
    v_add_f32 v144, v144, v148
    v_add_f32 v145, v145, v149
    v_add_f32 v146, v146, v150
    v_add_f32 v147, v147, v151
    v_and_b32 v144, 0x7fffffff, v144
    v_and_b32 v145, 0x7fffffff, v145
    v_and_b32 v146, 0x7fffffff, v146
    v_and_b32 v147, 0x7fffffff, v147
    buffer_store_dwordx4 v[144:147], v2, s[56:59], s70 offen sc1
    s_setprio 0
    s_waitcnt vmcnt(0)
L_nored:
    v_and_b32 v5, 28, v1
    v_lshrrev_b32 v6, 5, v1
    v_lshl_add_u32 v5, v6, 1, v5
    v_mul_u32_u24 v5, 408, v5
    v_and_b32 v6, 3, v1
    v_lshl_add_u32 v2, v6, 3, v5
    s_mul_i32 s70, s62, 96
    v_add_u32 v2, s70, v2
    v_add_u32 v3, 52224, v2
    v_add_u32 v4, 104448, v2
    ds_read_b64_tr_b16 v[16:17], v2 offset:0
    ds_read_b64_tr_b16 v[18:19], v2 offset:408
    ds_read_b64_tr_b16 v[20:21], v2 offset:32
    ds_read_b64_tr_b16 v[22:23], v2 offset:440
    ds_read_b64_tr_b16 v[24:25], v2 offset:64
    ds_read_b64_tr_b16 v[26:27], v2 offset:472
    ds_read_b64_tr_b16 v[28:29], v2 offset:13056
    ds_read_b64_tr_b16 v[30:31], v2 offset:13464
    ds_read_b64_tr_b16 v[32:33], v2 offset:13088
    ds_read_b64_tr_b16 v[34:35], v2 offset:13496
    ds_read_b64_tr_b16 v[36:37], v2 offset:13120
    ds_read_b64_tr_b16 v[38:39], v2 offset:13528
    ds_read_b64_tr_b16 v[40:41], v2 offset:26112
    ds_read_b64_tr_b16 v[42:43], v2 offset:26520
    ds_read_b64_tr_b16 v[44:45], v2 offset:26144
    ds_read_b64_tr_b16 v[46:47], v2 offset:26552
    ds_read_b64_tr_b16 v[48:49], v2 offset:26176
    ds_read_b64_tr_b16 v[50:51], v2 offset:26584
    ds_read_b64_tr_b16 v[52:53], v2 offset:39168
    ds_read_b64_tr_b16 v[54:55], v2 offset:39576
    ds_read_b64_tr_b16 v[56:57], v2 offset:39200
    ds_read_b64_tr_b16 v[58:59], v2 offset:39608
    ds_read_b64_tr_b16 v[60:61], v2 offset:39232
    ds_read_b64_tr_b16 v[62:63], v2 offset:39640
    ds_read_b64_tr_b16 v[64:65], v3 offset:0
    ds_read_b64_tr_b16 v[66:67], v3 offset:408
    ds_read_b64_tr_b16 v[68:69], v3 offset:32
    ds_read_b64_tr_b16 v[70:71], v3 offset:440
    ds_read_b64_tr_b16 v[72:73], v3 offset:64
    ds_read_b64_tr_b16 v[74:75], v3 offset:472
    ds_read_b64_tr_b16 v[76:77], v3 offset:13056
    ds_read_b64_tr_b16 v[78:79], v3 offset:13464
    ds_read_b64_tr_b16 v[80:81], v3 offset:13088
    ds_read_b64_tr_b16 v[82:83], v3 offset:13496
    ds_read_b64_tr_b16 v[84:85], v3 offset:13120
    ds_read_b64_tr_b16 v[86:87], v3 offset:13528
    ds_read_b64_tr_b16 v[88:89], v3 offset:26112
    ds_read_b64_tr_b16 v[90:91], v3 offset:26520
    ds_read_b64_tr_b16 v[92:93], v3 offset:26144
    ds_read_b64_tr_b16 v[94:95], v3 offset:26552
    ds_read_b64_tr_b16 v[96:97], v3 offset:26176
    ds_read_b64_tr_b16 v[98:99], v3 offset:26584
    ds_read_b64_tr_b16 v[100:101], v3 offset:39168
    ds_read_b64_tr_b16 v[102:103], v3 offset:39576
    ds_read_b64_tr_b16 v[104:105], v3 offset:39200
    ds_read_b64_tr_b16 v[106:107], v3 offset:39608
    ds_read_b64_tr_b16 v[108:109], v3 offset:39232
    ds_read_b64_tr_b16 v[110:111], v3 offset:39640
    ds_read_b64_tr_b16 v[112:113], v4 offset:0
    ds_read_b64_tr_b16 v[114:115], v4 offset:408
    ds_read_b64_tr_b16 v[116:117], v4 offset:32
    ds_read_b64_tr_b16 v[118:119], v4 offset:440
    ds_read_b64_tr_b16 v[120:121], v4 offset:64
    ds_read_b64_tr_b16 v[122:123], v4 offset:472
    ds_read_b64_tr_b16 v[124:125], v4 offset:13056
    ds_read_b64_tr_b16 v[126:127], v4 offset:13464
    ds_read_b64_tr_b16 v[128:129], v4 offset:13088
    ds_read_b64_tr_b16 v[130:131], v4 offset:13496
    ds_read_b64_tr_b16 v[132:133], v4 offset:13120
    ds_read_b64_tr_b16 v[134:135], v4 offset:13528
    ds_read_b64_tr_b16 v[136:137], v4 offset:26112
    ds_read_b64_tr_b16 v[138:139], v4 offset:26520
    ds_read_b64_tr_b16 v[140:141], v4 offset:26144
    ds_read_b64_tr_b16 v[142:143], v4 offset:26552
    ds_read_b64_tr_b16 v[144:145], v4 offset:26176
    ds_read_b64_tr_b16 v[146:147], v4 offset:26584
    ds_read_b64_tr_b16 v[148:149], v4 offset:39168
    ds_read_b64_tr_b16 v[150:151], v4 offset:39576
    ds_read_b64_tr_b16 v[152:153], v4 offset:39200
    ds_read_b64_tr_b16 v[154:155], v4 offset:39608
    ds_read_b64_tr_b16 v[156:157], v4 offset:39232
    ds_read_b64_tr_b16 v[158:159], v4 offset:39640
    v_lshlrev_b32 v13, 16, v13
    v_lshlrev_b32 v14, 16, v14
    v_lshlrev_b32 v15, 16, v15
    v_mul_f32 v232, v13, v160
    v_mul_f32 v233, v13, v161
    v_mul_f32 v234, v13, v162
    v_mul_f32 v235, v13, v163
    v_mul_f32 v236, v13, v164
    v_mul_f32 v237, v13, v165
    v_mul_f32 v238, v13, v166
    v_mul_f32 v239, v13, v167
    v_mul_f32 v240, v13, v168
    v_mul_f32 v241, v13, v169
    v_mul_f32 v242, v13, v170
    v_mul_f32 v243, v13, v171
    v_mul_f32 v244, v13, v172
    v_mul_f32 v245, v13, v173
    v_mul_f32 v246, v13, v174
    v_mul_f32 v247, v13, v175
    v_mul_f32 v248, v13, v176
    v_mul_f32 v249, v13, v177
    v_mul_f32 v250, v13, v178
    v_mul_f32 v251, v13, v179
    v_mul_f32 v252, v13, v180
    v_mul_f32 v253, v13, v181
    v_mul_f32 v254, v13, v182
    v_mul_f32 v255, v13, v183
    v_fma_f32 v232, v14, v184, v232
    v_fma_f32 v233, v14, v185, v233
    v_fma_f32 v234, v14, v186, v234
    v_fma_f32 v235, v14, v187, v235
    v_fma_f32 v236, v14, v188, v236
    v_fma_f32 v237, v14, v189, v237
    v_fma_f32 v238, v14, v190, v238
    v_fma_f32 v239, v14, v191, v239
    v_fma_f32 v240, v14, v192, v240
    v_fma_f32 v241, v14, v193, v241
    v_fma_f32 v242, v14, v194, v242
    v_fma_f32 v243, v14, v195, v243
    v_fma_f32 v244, v14, v196, v244
    v_fma_f32 v245, v14, v197, v245
    v_fma_f32 v246, v14, v198, v246
    v_fma_f32 v247, v14, v199, v247
    v_fma_f32 v248, v14, v200, v248
    v_fma_f32 v249, v14, v201, v249
    v_fma_f32 v250, v14, v202, v250
    v_fma_f32 v251, v14, v203, v251
    v_fma_f32 v252, v14, v204, v252
    v_fma_f32 v253, v14, v205, v253
    v_fma_f32 v254, v14, v206, v254
    v_fma_f32 v255, v14, v207, v255
    v_fma_f32 v232, v15, v208, v232
    v_fma_f32 v233, v15, v209, v233
    v_fma_f32 v234, v15, v210, v234
    v_fma_f32 v235, v15, v211, v235
    v_fma_f32 v236, v15, v212, v236
    v_fma_f32 v237, v15, v213, v237
    v_fma_f32 v238, v15, v214, v238
    v_fma_f32 v239, v15, v215, v239
    v_fma_f32 v240, v15, v216, v240
    v_fma_f32 v241, v15, v217, v241
    v_fma_f32 v242, v15, v218, v242
    v_fma_f32 v243, v15, v219, v243
    v_fma_f32 v244, v15, v220, v244
    v_fma_f32 v245, v15, v221, v245
    v_fma_f32 v246, v15, v222, v246
    v_fma_f32 v247, v15, v223, v247
    v_fma_f32 v248, v15, v224, v248
    v_fma_f32 v249, v15, v225, v249
    v_fma_f32 v250, v15, v226, v250
    v_fma_f32 v251, v15, v227, v251
    v_fma_f32 v252, v15, v228, v252
    v_fma_f32 v253, v15, v229, v253
    v_fma_f32 v254, v15, v230, v254
    v_fma_f32 v255, v15, v231, v255
    v_permlane32_swap_b32 v232, v244
    v_permlane32_swap_b32 v233, v245
    v_permlane32_swap_b32 v234, v246
    v_permlane32_swap_b32 v235, v247
    v_permlane32_swap_b32 v236, v248
    v_permlane32_swap_b32 v237, v249
    v_permlane32_swap_b32 v238, v250
    v_permlane32_swap_b32 v239, v251
    v_permlane32_swap_b32 v240, v252
    v_permlane32_swap_b32 v241, v253
    v_permlane32_swap_b32 v242, v254
    v_permlane32_swap_b32 v243, v255
    v_add_f32 v232, v232, v244
    v_add_f32 v233, v233, v245
    v_add_f32 v234, v234, v246
    v_add_f32 v235, v235, v247
    v_add_f32 v236, v236, v248
    v_add_f32 v237, v237, v249
    v_add_f32 v238, v238, v250
    v_add_f32 v239, v239, v251
    v_add_f32 v240, v240, v252
    v_add_f32 v241, v241, v253
    v_add_f32 v242, v242, v254
    v_add_f32 v243, v243, v255
    s_cmp_lg_u32 s60, 3
    s_cbranch_scc1 L_nofin0
    buffer_load_dwordx2 v[248:249], v12, s[56:59], 0 offen offset:0 sc1
    buffer_load_dwordx2 v[250:251], v12, s[56:59], 0 offen offset:512 sc1
    buffer_load_dwordx2 v[252:253], v12, s[56:59], 0 offen offset:1024 sc1
L_nofin0:
    v_permlane16_swap_b32 v232, v238
    v_permlane16_swap_b32 v233, v239
    v_permlane16_swap_b32 v234, v240
    v_permlane16_swap_b32 v235, v241
    v_permlane16_swap_b32 v236, v242
    v_permlane16_swap_b32 v237, v243
    v_add_f32 v232, v232, v238
    v_add_f32 v233, v233, v239
    v_add_f32 v234, v234, v240
    v_add_f32 v235, v235, v241
    v_add_f32 v236, v236, v242
    v_add_f32 v237, v237, v243
    v_add_f32_dpp v232, v232, v232 row_shr:4 row_mask:0xf bank_mask:0xf bound_ctrl:0
    v_add_f32_dpp v233, v233, v233 row_shr:4 row_mask:0xf bank_mask:0xf bound_ctrl:0
    v_add_f32_dpp v234, v234, v234 row_shr:4 row_mask:0xf bank_mask:0xf bound_ctrl:0
    v_add_f32_dpp v235, v235, v235 row_shr:4 row_mask:0xf bank_mask:0xf bound_ctrl:0
    v_add_f32_dpp v236, v236, v236 row_shr:4 row_mask:0xf bank_mask:0xf bound_ctrl:0
    v_add_f32_dpp v237, v237, v237 row_shr:4 row_mask:0xf bank_mask:0xf bound_ctrl:0
    v_add_f32_dpp v232, v232, v232 row_shr:8 row_mask:0xf bank_mask:0xf bound_ctrl:0
    v_add_f32_dpp v233, v233, v233 row_shr:8 row_mask:0xf bank_mask:0xf bound_ctrl:0
    v_add_f32_dpp v234, v234, v234 row_shr:8 row_mask:0xf bank_mask:0xf bound_ctrl:0
    v_add_f32_dpp v235, v235, v235 row_shr:8 row_mask:0xf bank_mask:0xf bound_ctrl:0
    v_add_f32_dpp v236, v236, v236 row_shr:8 row_mask:0xf bank_mask:0xf bound_ctrl:0
    v_add_f32_dpp v237, v237, v237 row_shr:8 row_mask:0xf bank_mask:0xf bound_ctrl:0
    v_and_b32 v13, 3, v1
    v_mul_u32_u24 v13, 96, v13
    v_lshrrev_b32 v14, 4, v1
    v_mul_u32_u24 v14, 24, v14
    v_add_u32 v13, 162816, v13
    v_add_u32 v13, v13, v14
    s_mov_b32 exec_lo, 0xf000f000
    s_mov_b32 exec_hi, 0xf000f000
    ds_add_f32 v13, v232 offset:0
    ds_add_f32 v13, v233 offset:4
    ds_add_f32 v13, v234 offset:8
    ds_add_f32 v13, v235 offset:12
    ds_add_f32 v13, v236 offset:16
    ds_add_f32 v13, v237 offset:20
    s_mov_b64 exec, -1
    s_cmp_lg_u32 s60, 3
    s_cbranch_scc1 L_nofin
    v_lshlrev_b32 v13, 3, v1
    v_add_u32 v13, 156672, v13
    s_mov_b32 s75, 0x20000
    s_waitcnt lgkmcnt(0)
    v_lshlrev_b32 v240, 16, v8
    v_and_b32 v241, s66, v8
    v_lshlrev_b32 v242, 16, v9
    v_and_b32 v243, s66, v9
    v_lshlrev_b32 v244, 16, v10
    v_and_b32 v245, s66, v10
    s_mov_b32 s70, 1083289508
    s_mov_b32 s71, 897988541
    s_mov_b32 s72, 3221786265
    v_mov_b32 v15, s71
    s_setprio 2
L_finpoll:
    s_waitcnt vmcnt(0)
    v_or3_b32 v238, v248, v249, v250
    v_or3_b32 v238, v238, v251, v252
    v_or_b32 v238, v238, v253
    v_cmp_gt_i32 vcc, 0, v238
    s_cbranch_vccz L_finok1
    buffer_load_dwordx2 v[248:249], v12, s[56:59], 0 offen offset:0 sc1
    buffer_load_dwordx2 v[250:251], v12, s[56:59], 0 offen offset:512 sc1
    buffer_load_dwordx2 v[252:253], v12, s[56:59], 0 offen offset:1024 sc1
    s_sub_u32 s75, s75, 1
    s_cbranch_scc0 L_finpoll
L_finok1:
    v_fma_f32 v2, v248, s70, v15
    v_fma_f32 v3, v249, s70, v15
    v_fma_f32 v8, v250, s70, v15
    v_fma_f32 v9, v251, s70, v15
    v_fma_f32 v254, v252, s70, v15
    v_fma_f32 v255, v253, s70, v15
L_finjoin:
    v_sqrt_f32 v2, v2
    v_sqrt_f32 v3, v3
    v_sqrt_f32 v8, v8
    v_sqrt_f32 v9, v9
    v_sqrt_f32 v254, v254
    v_sqrt_f32 v255, v255
    s_nop 0
    v_add_f32 v238, v2, v3
    v_add_f32 v239, v8, v9
    v_add_f32 v246, v254, v255
    v_add_f32 v238, v238, v239
    v_add_f32 v238, v238, v246
    v_mul_f32 v2, v2, v240
    v_mul_f32 v3, v3, v241
    v_mul_f32 v8, v8, v242
    v_mul_f32 v9, v9, v243
    v_mul_f32 v254, v254, v244
    v_mul_f32 v255, v255, v245
    s_nop 1
    v_add_f32_dpp v238, v238, v238 row_shr:1 row_mask:0xf bank_mask:0xf bound_ctrl:0
    s_nop 1
    v_add_f32_dpp v238, v238, v238 row_shr:2 row_mask:0xf bank_mask:0xf bound_ctrl:0
    s_nop 1
    v_add_f32_dpp v238, v238, v238 row_shr:4 row_mask:0xf bank_mask:0xf bound_ctrl:0
    s_nop 1
    v_add_f32_dpp v238, v238, v238 row_shr:8 row_mask:0xf bank_mask:0xf bound_ctrl:0
    s_nop 1
    v_add_f32_dpp v238, v238, v238 row_bcast:15 row_mask:0xa bank_mask:0xf
    s_nop 1
    v_add_f32_dpp v238, v238, v238 row_bcast:31 row_mask:0xc bank_mask:0xf
    s_nop 1
    v_readlane_b32 s73, v238, 63
    v_mov_b32 v239, 992651947
    s_nop 1
    v_fma_f32 v238, s73, v239, v15
    v_rcp_f32 v238, v238
    s_nop 0
    v_mul_f32 v238, s72, v238
    v_mov_b32 v239, s72
    v_fma_f32 v2, v2, v238, v239
    v_fma_f32 v3, v3, v238, v239
    v_fma_f32 v8, v8, v238, v239
    v_fma_f32 v9, v9, v238, v239
    v_fma_f32 v254, v254, v238, v239
    v_fma_f32 v255, v255, v238, v239
    ds_write_b64 v13, v[2:3] offset:0
    ds_write_b64 v13, v[8:9] offset:512
    ds_write_b64 v13, v[254:255] offset:1024
    s_waitcnt lgkmcnt(0)
    s_setprio 0
    s_waitcnt vmcnt(0)
L_nofin:
    s_mul_i32 s70, s63, 96
    v_mul_u32_u24 v6, 24, v6
    v_add3_u32 v2, v5, v6, s70
    v_add_u32 v3, 52224, v2
    v_add_u32 v4, 104448, v2
    v_add_u32 v8, 384, v5
    v_add_u32 v9, 52224, v8
    v_add_u32 v10, 104448, v8
    v_and_b32 v5, 15, v1
    v_lshrrev_b32 v6, 4, v1
    s_mul_i32 s71, s62, 48
    s_add_u32 s72, s70, s61
    s_mov_b32 s74, 0x12492493
    v_mul_u32_u24 v1, 24, v6
    v_add_u32 v1, s72, v1
    v_add_u32 v12, s71, v5
    v_mov_b32 v0, v12
    v_mul_hi_u32 v12, v0, s74
    v_mul_u32_u24 v12, 210, v12
    v_add_u32 v12, v12, v0
    v_mul_u32_u24 v12, 192, v12
    v_add_u32 v12, v12, v1
    v_add_u32 v0, 16, v0
    v_mul_hi_u32 v13, v0, s74
    v_mul_u32_u24 v13, 210, v13
    v_add_u32 v13, v13, v0
    v_mul_u32_u24 v13, 192, v13
    v_add_u32 v13, v13, v1
    v_add_u32 v0, 16, v0
    v_mul_hi_u32 v14, v0, s74
    v_mul_u32_u24 v14, 210, v14
    v_add_u32 v14, v14, v0
    v_mul_u32_u24 v14, 192, v14
    v_add_u32 v14, v14, v1
    s_lshl_b32 s71, s62, 3
    s_add_u32 s71, s71, 561024
    v_mul_u32_u24 v15, 192, v5
    v_add3_u32 v15, v15, v1, s71
    v_mov_b32 v0, 0x7fffff00
    v_cmp_gt_u32 vcc, 4, v5
    s_nop 1
    v_cndmask_b32 v15, v0, v15, vcc
    s_mul_i32 s70, s63, 192
    s_add_u32 s70, s70, 162816
    v_mul_u32_u24 v1, 48, v6
    v_add_u32 v1, s70, v1
    s_waitcnt lgkmcnt(0)
    s_barrier
    ds_read_b32 v0, v7 offset:0
    ds_read_b32 v6, v7 offset:512
    ds_read_b32 v5, v7 offset:1024
    v_add_u32 v7, 104448, v11
    s_waitcnt lgkmcnt(0)
    v_pk_mul_f32 v[160:161], v[160:161], v[0:1] op_sel_hi:[1,0]
    v_pk_mul_f32 v[162:163], v[162:163], v[0:1] op_sel_hi:[1,0]
    v_pk_mul_f32 v[164:165], v[164:165], v[0:1] op_sel_hi:[1,0]
    v_pk_mul_f32 v[166:167], v[166:167], v[0:1] op_sel_hi:[1,0]
    v_pk_mul_f32 v[168:169], v[168:169], v[0:1] op_sel_hi:[1,0]
    v_pk_mul_f32 v[170:171], v[170:171], v[0:1] op_sel_hi:[1,0]
    v_pk_mul_f32 v[172:173], v[172:173], v[0:1] op_sel_hi:[1,0]
    v_pk_mul_f32 v[174:175], v[174:175], v[0:1] op_sel_hi:[1,0]
    v_pk_mul_f32 v[176:177], v[176:177], v[0:1] op_sel_hi:[1,0]
    v_pk_mul_f32 v[178:179], v[178:179], v[0:1] op_sel_hi:[1,0]
    v_pk_mul_f32 v[180:181], v[180:181], v[0:1] op_sel_hi:[1,0]
    v_pk_mul_f32 v[182:183], v[182:183], v[0:1] op_sel_hi:[1,0]
    v_cvt_pk_bf16_f32 v232, v160, v161
    v_cvt_pk_bf16_f32 v233, v162, v163
    v_cvt_pk_bf16_f32 v234, v164, v165
    v_cvt_pk_bf16_f32 v235, v166, v167
    v_cvt_pk_bf16_f32 v236, v168, v169
    v_cvt_pk_bf16_f32 v237, v170, v171
    v_cvt_pk_bf16_f32 v238, v172, v173
    v_cvt_pk_bf16_f32 v239, v174, v175
    v_cvt_pk_bf16_f32 v240, v176, v177
    v_cvt_pk_bf16_f32 v241, v178, v179
    v_cvt_pk_bf16_f32 v242, v180, v181
    v_cvt_pk_bf16_f32 v243, v182, v183
    ds_write_b64 v11, v[232:233] offset:0
    ds_write_b64 v11, v[234:235] offset:8
    ds_write_b64 v11, v[236:237] offset:16
    ds_write_b64 v11, v[238:239] offset:24
    ds_write_b64 v11, v[240:241] offset:32
    ds_write_b64 v11, v[242:243] offset:40
    v_pk_mul_f32 v[184:185], v[184:185], v[6:7] op_sel_hi:[1,0]
    v_pk_mul_f32 v[186:187], v[186:187], v[6:7] op_sel_hi:[1,0]
    v_pk_mul_f32 v[188:189], v[188:189], v[6:7] op_sel_hi:[1,0]
    v_pk_mul_f32 v[190:191], v[190:191], v[6:7] op_sel_hi:[1,0]
    v_pk_mul_f32 v[192:193], v[192:193], v[6:7] op_sel_hi:[1,0]
    v_pk_mul_f32 v[194:195], v[194:195], v[6:7] op_sel_hi:[1,0]
    v_pk_mul_f32 v[196:197], v[196:197], v[6:7] op_sel_hi:[1,0]
    v_pk_mul_f32 v[198:199], v[198:199], v[6:7] op_sel_hi:[1,0]
    v_pk_mul_f32 v[200:201], v[200:201], v[6:7] op_sel_hi:[1,0]
    v_pk_mul_f32 v[202:203], v[202:203], v[6:7] op_sel_hi:[1,0]
    v_pk_mul_f32 v[204:205], v[204:205], v[6:7] op_sel_hi:[1,0]
    v_pk_mul_f32 v[206:207], v[206:207], v[6:7] op_sel_hi:[1,0]
    v_cvt_pk_bf16_f32 v244, v184, v185
    v_cvt_pk_bf16_f32 v245, v186, v187
    v_cvt_pk_bf16_f32 v246, v188, v189
    v_cvt_pk_bf16_f32 v247, v190, v191
    v_cvt_pk_bf16_f32 v248, v192, v193
    v_cvt_pk_bf16_f32 v249, v194, v195
    v_cvt_pk_bf16_f32 v250, v196, v197
    v_cvt_pk_bf16_f32 v251, v198, v199
    v_cvt_pk_bf16_f32 v252, v200, v201
    v_cvt_pk_bf16_f32 v253, v202, v203
    v_cvt_pk_bf16_f32 v254, v204, v205
    v_cvt_pk_bf16_f32 v255, v206, v207
    ds_write_b64 v11, v[244:245] offset:52224
    ds_write_b64 v11, v[246:247] offset:52232
    ds_write_b64 v11, v[248:249] offset:52240
    ds_write_b64 v11, v[250:251] offset:52248
    ds_write_b64 v11, v[252:253] offset:52256
    ds_write_b64 v11, v[254:255] offset:52264
    v_pk_mul_f32 v[208:209], v[208:209], v[4:5] op_sel:[0,1]
    v_pk_mul_f32 v[210:211], v[210:211], v[4:5] op_sel:[0,1]
    v_pk_mul_f32 v[212:213], v[212:213], v[4:5] op_sel:[0,1]
    v_pk_mul_f32 v[214:215], v[214:215], v[4:5] op_sel:[0,1]
    v_pk_mul_f32 v[216:217], v[216:217], v[4:5] op_sel:[0,1]
    v_pk_mul_f32 v[218:219], v[218:219], v[4:5] op_sel:[0,1]
    v_pk_mul_f32 v[220:221], v[220:221], v[4:5] op_sel:[0,1]
    v_pk_mul_f32 v[222:223], v[222:223], v[4:5] op_sel:[0,1]
    v_pk_mul_f32 v[224:225], v[224:225], v[4:5] op_sel:[0,1]
    v_pk_mul_f32 v[226:227], v[226:227], v[4:5] op_sel:[0,1]
    v_pk_mul_f32 v[228:229], v[228:229], v[4:5] op_sel:[0,1]
    v_pk_mul_f32 v[230:231], v[230:231], v[4:5] op_sel:[0,1]
    v_cvt_pk_bf16_f32 v232, v208, v209
    v_cvt_pk_bf16_f32 v233, v210, v211
    v_cvt_pk_bf16_f32 v234, v212, v213
    v_cvt_pk_bf16_f32 v235, v214, v215
    v_cvt_pk_bf16_f32 v236, v216, v217
    v_cvt_pk_bf16_f32 v237, v218, v219
    v_cvt_pk_bf16_f32 v238, v220, v221
    v_cvt_pk_bf16_f32 v239, v222, v223
    v_cvt_pk_bf16_f32 v240, v224, v225
    v_cvt_pk_bf16_f32 v241, v226, v227
    v_cvt_pk_bf16_f32 v242, v228, v229
    v_cvt_pk_bf16_f32 v243, v230, v231
    ds_write2_b64 v7, v[232:233], v[234:235] offset0:0 offset1:1
    ds_write2_b64 v7, v[236:237], v[238:239] offset0:2 offset1:3
    ds_write2_b64 v7, v[240:241], v[242:243] offset0:4 offset1:5
    ds_read_b128 v[160:163], v1 offset:0
    ds_read_b128 v[164:167], v1 offset:16
    ds_read_b128 v[168:171], v1 offset:32
    ds_read_b128 v[172:175], v1 offset:0
    ds_read_b128 v[176:179], v1 offset:16
    ds_read_b128 v[180:183], v1 offset:32
    ds_read_b128 v[184:187], v1 offset:0
    ds_read_b128 v[188:191], v1 offset:16
    ds_read_b128 v[192:195], v1 offset:32
    s_lshl_b32 s70, s62, 4
    v_add_u32 v1, s70, v1
    ds_read_b128 v[196:199], v1
    s_waitcnt lgkmcnt(0)
    s_barrier
    s_cmp_eq_u32 s62, 0
    s_cbranch_scc1 L_g2_0
    s_cmp_eq_u32 s62, 1
    s_cbranch_scc1 L_g2_1
    s_cmp_eq_u32 s62, 2
    s_cbranch_scc1 L_g2_2
L_g2_3:
    ds_read_b64_tr_b16 v[200:201], v2 offset:0
    ds_read_b64_tr_b16 v[202:203], v2 offset:408
    ds_read_b64_tr_b16 v[204:205], v2 offset:8
    ds_read_b64_tr_b16 v[206:207], v2 offset:416
    ds_read_b64_tr_b16 v[208:209], v2 offset:16
    ds_read_b64_tr_b16 v[210:211], v2 offset:424
    ds_read_b64_tr_b16 v[216:217], v2 offset:13056
    ds_read_b64_tr_b16 v[218:219], v2 offset:13464
    ds_read_b64_tr_b16 v[220:221], v2 offset:13064
    ds_read_b64_tr_b16 v[222:223], v2 offset:13472
    ds_read_b64_tr_b16 v[224:225], v2 offset:13072
    ds_read_b64_tr_b16 v[226:227], v2 offset:13480
    ds_read_b64_tr_b16 v[232:233], v2 offset:26112
    ds_read_b64_tr_b16 v[234:235], v2 offset:26520
    ds_read_b64_tr_b16 v[236:237], v2 offset:26120
    ds_read_b64_tr_b16 v[238:239], v2 offset:26528
    ds_read_b64_tr_b16 v[240:241], v2 offset:26128
    ds_read_b64_tr_b16 v[242:243], v2 offset:26536
    s_waitcnt lgkmcnt(12)
    v_mfma_f32_16x16x32_bf16 v[160:163], v[200:203], v[16:19], v[160:163]
    v_mfma_f32_16x16x32_bf16 v[172:175], v[200:203], v[20:23], v[172:175]
    v_mfma_f32_16x16x32_bf16 v[184:187], v[200:203], v[24:27], v[184:187]
    v_mfma_f32_16x16x32_bf16 v[164:167], v[204:207], v[16:19], v[164:167]
    v_mfma_f32_16x16x32_bf16 v[176:179], v[204:207], v[20:23], v[176:179]
    v_mfma_f32_16x16x32_bf16 v[188:191], v[204:207], v[24:27], v[188:191]
    v_mfma_f32_16x16x32_bf16 v[168:171], v[208:211], v[16:19], v[168:171]
    v_mfma_f32_16x16x32_bf16 v[180:183], v[208:211], v[20:23], v[180:183]
    v_mfma_f32_16x16x32_bf16 v[192:195], v[208:211], v[24:27], v[192:195]
    ds_read_b64_tr_b16 v[200:201], v2 offset:39168
    ds_read_b64_tr_b16 v[202:203], v2 offset:39576
    ds_read_b64_tr_b16 v[204:205], v2 offset:39176
    ds_read_b64_tr_b16 v[206:207], v2 offset:39584
    ds_read_b64_tr_b16 v[208:209], v2 offset:39184
    ds_read_b64_tr_b16 v[210:211], v2 offset:39592
    s_waitcnt lgkmcnt(12)
    v_mfma_f32_16x16x32_bf16 v[160:163], v[216:219], v[28:31], v[160:163]
    v_mfma_f32_16x16x32_bf16 v[172:175], v[216:219], v[32:35], v[172:175]
    v_mfma_f32_16x16x32_bf16 v[184:187], v[216:219], v[36:39], v[184:187]
    v_mfma_f32_16x16x32_bf16 v[164:167], v[220:223], v[28:31], v[164:167]
    v_mfma_f32_16x16x32_bf16 v[176:179], v[220:223], v[32:35], v[176:179]
    v_mfma_f32_16x16x32_bf16 v[188:191], v[220:223], v[36:39], v[188:191]
    v_mfma_f32_16x16x32_bf16 v[168:171], v[224:227], v[28:31], v[168:171]
    v_mfma_f32_16x16x32_bf16 v[180:183], v[224:227], v[32:35], v[180:183]
    v_mfma_f32_16x16x32_bf16 v[192:195], v[224:227], v[36:39], v[192:195]
    ds_read_b64_tr_b16 v[216:217], v3 offset:0
    ds_read_b64_tr_b16 v[218:219], v3 offset:408
    ds_read_b64_tr_b16 v[220:221], v3 offset:8
    ds_read_b64_tr_b16 v[222:223], v3 offset:416
    ds_read_b64_tr_b16 v[224:225], v3 offset:16
    ds_read_b64_tr_b16 v[226:227], v3 offset:424
    s_waitcnt lgkmcnt(12)
    v_mfma_f32_16x16x32_bf16 v[160:163], v[232:235], v[40:43], v[160:163]
    v_mfma_f32_16x16x32_bf16 v[172:175], v[232:235], v[44:47], v[172:175]
    v_mfma_f32_16x16x32_bf16 v[184:187], v[232:235], v[48:51], v[184:187]
    v_mfma_f32_16x16x32_bf16 v[164:167], v[236:239], v[40:43], v[164:167]
    v_mfma_f32_16x16x32_bf16 v[176:179], v[236:239], v[44:47], v[176:179]
    v_mfma_f32_16x16x32_bf16 v[188:191], v[236:239], v[48:51], v[188:191]
    v_mfma_f32_16x16x32_bf16 v[168:171], v[240:243], v[40:43], v[168:171]
    v_mfma_f32_16x16x32_bf16 v[180:183], v[240:243], v[44:47], v[180:183]
    v_mfma_f32_16x16x32_bf16 v[192:195], v[240:243], v[48:51], v[192:195]
    buffer_load_dwordx4 v[16:19], v12, s[24:27], 0 offen
    buffer_load_dwordx2 v[20:21], v12, s[24:27], 0 offen offset:16
    buffer_load_dwordx4 v[22:25], v13, s[24:27], 0 offen
    buffer_load_dwordx2 v[26:27], v13, s[24:27], 0 offen offset:16
    buffer_load_dwordx4 v[28:31], v14, s[24:27], 0 offen
    buffer_load_dwordx2 v[32:33], v14, s[24:27], 0 offen offset:16
    buffer_load_dwordx2 v[34:35], v15, s[24:27], 0 offen
    ds_read_b64_tr_b16 v[232:233], v3 offset:13056
    ds_read_b64_tr_b16 v[234:235], v3 offset:13464
    ds_read_b64_tr_b16 v[236:237], v3 offset:13064
    ds_read_b64_tr_b16 v[238:239], v3 offset:13472
    ds_read_b64_tr_b16 v[240:241], v3 offset:13072
    ds_read_b64_tr_b16 v[242:243], v3 offset:13480
    s_waitcnt lgkmcnt(12)
    v_mfma_f32_16x16x32_bf16 v[160:163], v[200:203], v[52:55], v[160:163]
    v_mfma_f32_16x16x32_bf16 v[172:175], v[200:203], v[56:59], v[172:175]
    v_mfma_f32_16x16x32_bf16 v[184:187], v[200:203], v[60:63], v[184:187]
    v_mfma_f32_16x16x32_bf16 v[164:167], v[204:207], v[52:55], v[164:167]
    v_mfma_f32_16x16x32_bf16 v[176:179], v[204:207], v[56:59], v[176:179]
    v_mfma_f32_16x16x32_bf16 v[188:191], v[204:207], v[60:63], v[188:191]
    v_mfma_f32_16x16x32_bf16 v[168:171], v[208:211], v[52:55], v[168:171]
    v_mfma_f32_16x16x32_bf16 v[180:183], v[208:211], v[56:59], v[180:183]
    v_mfma_f32_16x16x32_bf16 v[192:195], v[208:211], v[60:63], v[192:195]
    ds_read_b64_tr_b16 v[200:201], v3 offset:26112
    ds_read_b64_tr_b16 v[202:203], v3 offset:26520
    ds_read_b64_tr_b16 v[204:205], v3 offset:26120
    ds_read_b64_tr_b16 v[206:207], v3 offset:26528
    ds_read_b64_tr_b16 v[208:209], v3 offset:26128
    ds_read_b64_tr_b16 v[210:211], v3 offset:26536
    s_waitcnt lgkmcnt(12)
    v_mfma_f32_16x16x32_bf16 v[160:163], v[216:219], v[64:67], v[160:163]
    v_mfma_f32_16x16x32_bf16 v[172:175], v[216:219], v[68:71], v[172:175]
    v_mfma_f32_16x16x32_bf16 v[184:187], v[216:219], v[72:75], v[184:187]
    v_mfma_f32_16x16x32_bf16 v[164:167], v[220:223], v[64:67], v[164:167]
    v_mfma_f32_16x16x32_bf16 v[176:179], v[220:223], v[68:71], v[176:179]
    v_mfma_f32_16x16x32_bf16 v[188:191], v[220:223], v[72:75], v[188:191]
    v_mfma_f32_16x16x32_bf16 v[168:171], v[224:227], v[64:67], v[168:171]
    v_mfma_f32_16x16x32_bf16 v[180:183], v[224:227], v[68:71], v[180:183]
    v_mfma_f32_16x16x32_bf16 v[192:195], v[224:227], v[72:75], v[192:195]
    ds_read_b64_tr_b16 v[216:217], v3 offset:39168
    ds_read_b64_tr_b16 v[218:219], v3 offset:39576
    ds_read_b64_tr_b16 v[220:221], v3 offset:39176
    ds_read_b64_tr_b16 v[222:223], v3 offset:39584
    ds_read_b64_tr_b16 v[224:225], v3 offset:39184
    ds_read_b64_tr_b16 v[226:227], v3 offset:39592
    s_waitcnt lgkmcnt(12)
    v_mfma_f32_16x16x32_bf16 v[160:163], v[232:235], v[76:79], v[160:163]
    v_mfma_f32_16x16x32_bf16 v[172:175], v[232:235], v[80:83], v[172:175]
    v_mfma_f32_16x16x32_bf16 v[184:187], v[232:235], v[84:87], v[184:187]
    v_mfma_f32_16x16x32_bf16 v[164:167], v[236:239], v[76:79], v[164:167]
    v_mfma_f32_16x16x32_bf16 v[176:179], v[236:239], v[80:83], v[176:179]
    v_mfma_f32_16x16x32_bf16 v[188:191], v[236:239], v[84:87], v[188:191]
    v_mfma_f32_16x16x32_bf16 v[168:171], v[240:243], v[76:79], v[168:171]
    v_mfma_f32_16x16x32_bf16 v[180:183], v[240:243], v[80:83], v[180:183]
    v_mfma_f32_16x16x32_bf16 v[192:195], v[240:243], v[84:87], v[192:195]
    ds_read_b64_tr_b16 v[232:233], v4 offset:0
    ds_read_b64_tr_b16 v[234:235], v4 offset:408
    ds_read_b64_tr_b16 v[236:237], v4 offset:8
    ds_read_b64_tr_b16 v[238:239], v4 offset:416
    ds_read_b64_tr_b16 v[240:241], v4 offset:16
    ds_read_b64_tr_b16 v[242:243], v4 offset:424
    s_waitcnt lgkmcnt(12)
    v_mfma_f32_16x16x32_bf16 v[160:163], v[200:203], v[88:91], v[160:163]
    v_mfma_f32_16x16x32_bf16 v[172:175], v[200:203], v[92:95], v[172:175]
    v_mfma_f32_16x16x32_bf16 v[184:187], v[200:203], v[96:99], v[184:187]
    v_mfma_f32_16x16x32_bf16 v[164:167], v[204:207], v[88:91], v[164:167]
    v_mfma_f32_16x16x32_bf16 v[176:179], v[204:207], v[92:95], v[176:179]
    v_mfma_f32_16x16x32_bf16 v[188:191], v[204:207], v[96:99], v[188:191]
    v_mfma_f32_16x16x32_bf16 v[168:171], v[208:211], v[88:91], v[168:171]
    v_mfma_f32_16x16x32_bf16 v[180:183], v[208:211], v[92:95], v[180:183]
    v_mfma_f32_16x16x32_bf16 v[192:195], v[208:211], v[96:99], v[192:195]
    ds_read_b64_tr_b16 v[200:201], v4 offset:13056
    ds_read_b64_tr_b16 v[202:203], v4 offset:13464
    ds_read_b64_tr_b16 v[204:205], v4 offset:13064
    ds_read_b64_tr_b16 v[206:207], v4 offset:13472
    ds_read_b64_tr_b16 v[208:209], v4 offset:13072
    ds_read_b64_tr_b16 v[210:211], v4 offset:13480
    s_waitcnt lgkmcnt(12)
    v_mfma_f32_16x16x32_bf16 v[160:163], v[216:219], v[100:103], v[160:163]
    v_mfma_f32_16x16x32_bf16 v[172:175], v[216:219], v[104:107], v[172:175]
    v_mfma_f32_16x16x32_bf16 v[184:187], v[216:219], v[108:111], v[184:187]
    v_mfma_f32_16x16x32_bf16 v[164:167], v[220:223], v[100:103], v[164:167]
    v_mfma_f32_16x16x32_bf16 v[176:179], v[220:223], v[104:107], v[176:179]
    v_mfma_f32_16x16x32_bf16 v[188:191], v[220:223], v[108:111], v[188:191]
    v_mfma_f32_16x16x32_bf16 v[168:171], v[224:227], v[100:103], v[168:171]
    v_mfma_f32_16x16x32_bf16 v[180:183], v[224:227], v[104:107], v[180:183]
    v_mfma_f32_16x16x32_bf16 v[192:195], v[224:227], v[108:111], v[192:195]
    ds_read_b64_tr_b16 v[216:217], v4 offset:26112
    ds_read_b64_tr_b16 v[218:219], v4 offset:26520
    ds_read_b64_tr_b16 v[220:221], v4 offset:26120
    ds_read_b64_tr_b16 v[222:223], v4 offset:26528
    ds_read_b64_tr_b16 v[224:225], v4 offset:26128
    ds_read_b64_tr_b16 v[226:227], v4 offset:26536
    s_waitcnt lgkmcnt(12)
    v_mfma_f32_16x16x32_bf16 v[160:163], v[232:235], v[112:115], v[160:163]
    v_mfma_f32_16x16x32_bf16 v[172:175], v[232:235], v[116:119], v[172:175]
    v_mfma_f32_16x16x32_bf16 v[184:187], v[232:235], v[120:123], v[184:187]
    v_mfma_f32_16x16x32_bf16 v[164:167], v[236:239], v[112:115], v[164:167]
    v_mfma_f32_16x16x32_bf16 v[176:179], v[236:239], v[116:119], v[176:179]
    v_mfma_f32_16x16x32_bf16 v[188:191], v[236:239], v[120:123], v[188:191]
    v_mfma_f32_16x16x32_bf16 v[168:171], v[240:243], v[112:115], v[168:171]
    v_mfma_f32_16x16x32_bf16 v[180:183], v[240:243], v[116:119], v[180:183]
    v_mfma_f32_16x16x32_bf16 v[192:195], v[240:243], v[120:123], v[192:195]
    s_waitcnt vmcnt(0)
    v_lshlrev_b32 v40, 16, v16
    v_and_b32 v41, s66, v16
    v_lshlrev_b32 v42, 16, v17
    v_and_b32 v43, s66, v17
    v_lshlrev_b32 v44, 16, v18
    v_and_b32 v45, s66, v18
    v_lshlrev_b32 v46, 16, v19
    v_and_b32 v47, s66, v19
    v_lshlrev_b32 v48, 16, v20
    v_and_b32 v49, s66, v20
    ds_read_b64_tr_b16 v[232:233], v4 offset:39168
    ds_read_b64_tr_b16 v[234:235], v4 offset:39576
    ds_read_b64_tr_b16 v[236:237], v4 offset:39176
    ds_read_b64_tr_b16 v[238:239], v4 offset:39584
    ds_read_b64_tr_b16 v[240:241], v4 offset:39184
    ds_read_b64_tr_b16 v[242:243], v4 offset:39592
    s_waitcnt lgkmcnt(12)
    v_mfma_f32_16x16x32_bf16 v[160:163], v[200:203], v[124:127], v[160:163]
    v_mfma_f32_16x16x32_bf16 v[172:175], v[200:203], v[128:131], v[172:175]
    v_mfma_f32_16x16x32_bf16 v[184:187], v[200:203], v[132:135], v[184:187]
    v_mfma_f32_16x16x32_bf16 v[164:167], v[204:207], v[124:127], v[164:167]
    v_mfma_f32_16x16x32_bf16 v[176:179], v[204:207], v[128:131], v[176:179]
    v_mfma_f32_16x16x32_bf16 v[188:191], v[204:207], v[132:135], v[188:191]
    v_mfma_f32_16x16x32_bf16 v[168:171], v[208:211], v[124:127], v[168:171]
    v_mfma_f32_16x16x32_bf16 v[180:183], v[208:211], v[128:131], v[180:183]
    v_mfma_f32_16x16x32_bf16 v[192:195], v[208:211], v[132:135], v[192:195]
    v_lshlrev_b32 v50, 16, v21
    v_and_b32 v51, s66, v21
    v_lshlrev_b32 v52, 16, v22
    v_and_b32 v53, s66, v22
    v_lshlrev_b32 v54, 16, v23
    v_and_b32 v55, s66, v23
    v_lshlrev_b32 v56, 16, v24
    v_and_b32 v57, s66, v24
    v_lshlrev_b32 v58, 16, v25
    v_and_b32 v59, s66, v25
    s_waitcnt lgkmcnt(6)
    v_mfma_f32_16x16x32_bf16 v[160:163], v[216:219], v[136:139], v[160:163]
    v_mfma_f32_16x16x32_bf16 v[172:175], v[216:219], v[140:143], v[172:175]
    v_mfma_f32_16x16x32_bf16 v[184:187], v[216:219], v[144:147], v[184:187]
    v_mfma_f32_16x16x32_bf16 v[164:167], v[220:223], v[136:139], v[164:167]
    v_mfma_f32_16x16x32_bf16 v[176:179], v[220:223], v[140:143], v[176:179]
    v_mfma_f32_16x16x32_bf16 v[188:191], v[220:223], v[144:147], v[188:191]
    v_mfma_f32_16x16x32_bf16 v[168:171], v[224:227], v[136:139], v[168:171]
    v_mfma_f32_16x16x32_bf16 v[180:183], v[224:227], v[140:143], v[180:183]
    v_mfma_f32_16x16x32_bf16 v[192:195], v[224:227], v[144:147], v[192:195]
    v_lshlrev_b32 v60, 16, v26
    v_and_b32 v61, s66, v26
    v_lshlrev_b32 v62, 16, v27
    v_and_b32 v63, s66, v27
    v_lshlrev_b32 v64, 16, v28
    v_and_b32 v65, s66, v28
    v_lshlrev_b32 v66, 16, v29
    v_and_b32 v67, s66, v29
    v_lshlrev_b32 v68, 16, v30
    v_and_b32 v69, s66, v30
    s_waitcnt lgkmcnt(0)
    v_mfma_f32_16x16x32_bf16 v[160:163], v[232:235], v[148:151], v[160:163]
    v_mfma_f32_16x16x32_bf16 v[172:175], v[232:235], v[152:155], v[172:175]
    v_mfma_f32_16x16x32_bf16 v[184:187], v[232:235], v[156:159], v[184:187]
    v_mfma_f32_16x16x32_bf16 v[164:167], v[236:239], v[148:151], v[164:167]
    v_mfma_f32_16x16x32_bf16 v[176:179], v[236:239], v[152:155], v[176:179]
    v_mfma_f32_16x16x32_bf16 v[188:191], v[236:239], v[156:159], v[188:191]
    v_mfma_f32_16x16x32_bf16 v[168:171], v[240:243], v[148:151], v[168:171]
    v_mfma_f32_16x16x32_bf16 v[180:183], v[240:243], v[152:155], v[180:183]
    v_mfma_f32_16x16x32_bf16 v[192:195], v[240:243], v[156:159], v[192:195]
    v_lshlrev_b32 v70, 16, v31
    v_and_b32 v71, s66, v31
    v_lshlrev_b32 v72, 16, v32
    v_and_b32 v73, s66, v32
    v_lshlrev_b32 v74, 16, v33
    v_and_b32 v75, s66, v33
    v_lshlrev_b32 v76, 16, v34
    v_and_b32 v77, s66, v34
    v_lshlrev_b32 v78, 16, v35
    v_and_b32 v79, s66, v35
    s_branch L_epi
L_g2_0:
    ds_read_b64_tr_b16 v[200:201], v2 offset:0
    ds_read_b64_tr_b16 v[202:203], v2 offset:408
    ds_read_b64_tr_b16 v[204:205], v2 offset:8
    ds_read_b64_tr_b16 v[206:207], v2 offset:416
    ds_read_b64_tr_b16 v[208:209], v2 offset:16
    ds_read_b64_tr_b16 v[210:211], v2 offset:424
    ds_read_b64_tr_b16 v[212:213], v8 offset:0
    ds_read_b64_tr_b16 v[214:215], v8 offset:408
    ds_read_b64_tr_b16 v[216:217], v2 offset:13056
    ds_read_b64_tr_b16 v[218:219], v2 offset:13464
    ds_read_b64_tr_b16 v[220:221], v2 offset:13064
    ds_read_b64_tr_b16 v[222:223], v2 offset:13472
    ds_read_b64_tr_b16 v[224:225], v2 offset:13072
    ds_read_b64_tr_b16 v[226:227], v2 offset:13480
    ds_read_b64_tr_b16 v[228:229], v8 offset:13056
    ds_read_b64_tr_b16 v[230:231], v8 offset:13464
    ds_read_b64_tr_b16 v[232:233], v2 offset:26112
    ds_read_b64_tr_b16 v[234:235], v2 offset:26520
    ds_read_b64_tr_b16 v[236:237], v2 offset:26120
    ds_read_b64_tr_b16 v[238:239], v2 offset:26528
    ds_read_b64_tr_b16 v[240:241], v2 offset:26128
    ds_read_b64_tr_b16 v[242:243], v2 offset:26536
    ds_read_b64_tr_b16 v[244:245], v8 offset:26112
    ds_read_b64_tr_b16 v[246:247], v8 offset:26520
    s_waitcnt lgkmcnt(15)
    v_mfma_f32_16x16x32_bf16 v[160:163], v[200:203], v[16:19], v[160:163]
    v_mfma_f32_16x16x32_bf16 v[172:175], v[200:203], v[20:23], v[172:175]
    v_mfma_f32_16x16x32_bf16 v[184:187], v[200:203], v[24:27], v[184:187]
    v_mfma_f32_16x16x32_bf16 v[164:167], v[204:207], v[16:19], v[164:167]
    v_mfma_f32_16x16x32_bf16 v[176:179], v[204:207], v[20:23], v[176:179]
    v_mfma_f32_16x16x32_bf16 v[188:191], v[204:207], v[24:27], v[188:191]
    v_mfma_f32_16x16x32_bf16 v[168:171], v[208:211], v[16:19], v[168:171]
    v_mfma_f32_16x16x32_bf16 v[180:183], v[208:211], v[20:23], v[180:183]
    v_mfma_f32_16x16x32_bf16 v[192:195], v[208:211], v[24:27], v[192:195]
    v_mfma_f32_16x16x32_bf16 v[196:199], v[200:203], v[212:215], v[196:199]
    ds_read_b64_tr_b16 v[200:201], v2 offset:39168
    ds_read_b64_tr_b16 v[202:203], v2 offset:39576
    ds_read_b64_tr_b16 v[204:205], v2 offset:39176
    ds_read_b64_tr_b16 v[206:207], v2 offset:39584
    ds_read_b64_tr_b16 v[208:209], v2 offset:39184
    ds_read_b64_tr_b16 v[210:211], v2 offset:39592
    ds_read_b64_tr_b16 v[212:213], v8 offset:39168
    ds_read_b64_tr_b16 v[214:215], v8 offset:39576
    s_waitcnt lgkmcnt(15)
    v_mfma_f32_16x16x32_bf16 v[160:163], v[216:219], v[28:31], v[160:163]
    v_mfma_f32_16x16x32_bf16 v[172:175], v[216:219], v[32:35], v[172:175]
    v_mfma_f32_16x16x32_bf16 v[184:187], v[216:219], v[36:39], v[184:187]
    v_mfma_f32_16x16x32_bf16 v[164:167], v[220:223], v[28:31], v[164:167]
    v_mfma_f32_16x16x32_bf16 v[176:179], v[220:223], v[32:35], v[176:179]
    v_mfma_f32_16x16x32_bf16 v[188:191], v[220:223], v[36:39], v[188:191]
    v_mfma_f32_16x16x32_bf16 v[168:171], v[224:227], v[28:31], v[168:171]
    v_mfma_f32_16x16x32_bf16 v[180:183], v[224:227], v[32:35], v[180:183]
    v_mfma_f32_16x16x32_bf16 v[192:195], v[224:227], v[36:39], v[192:195]
    v_mfma_f32_16x16x32_bf16 v[196:199], v[216:219], v[228:231], v[196:199]
    ds_read_b64_tr_b16 v[216:217], v3 offset:0
    ds_read_b64_tr_b16 v[218:219], v3 offset:408
    ds_read_b64_tr_b16 v[220:221], v3 offset:8
    ds_read_b64_tr_b16 v[222:223], v3 offset:416
    ds_read_b64_tr_b16 v[224:225], v3 offset:16
    ds_read_b64_tr_b16 v[226:227], v3 offset:424
    ds_read_b64_tr_b16 v[228:229], v9 offset:0
    ds_read_b64_tr_b16 v[230:231], v9 offset:408
    s_waitcnt lgkmcnt(15)
    v_mfma_f32_16x16x32_bf16 v[160:163], v[232:235], v[40:43], v[160:163]
    v_mfma_f32_16x16x32_bf16 v[172:175], v[232:235], v[44:47], v[172:175]
    v_mfma_f32_16x16x32_bf16 v[184:187], v[232:235], v[48:51], v[184:187]
    v_mfma_f32_16x16x32_bf16 v[164:167], v[236:239], v[40:43], v[164:167]
    v_mfma_f32_16x16x32_bf16 v[176:179], v[236:239], v[44:47], v[176:179]
    v_mfma_f32_16x16x32_bf16 v[188:191], v[236:239], v[48:51], v[188:191]
    v_mfma_f32_16x16x32_bf16 v[168:171], v[240:243], v[40:43], v[168:171]
    v_mfma_f32_16x16x32_bf16 v[180:183], v[240:243], v[44:47], v[180:183]
    v_mfma_f32_16x16x32_bf16 v[192:195], v[240:243], v[48:51], v[192:195]
    v_mfma_f32_16x16x32_bf16 v[196:199], v[232:235], v[244:247], v[196:199]
    buffer_load_dwordx4 v[16:19], v12, s[24:27], 0 offen
    buffer_load_dwordx2 v[20:21], v12, s[24:27], 0 offen offset:16
    buffer_load_dwordx4 v[22:25], v13, s[24:27], 0 offen
    buffer_load_dwordx2 v[26:27], v13, s[24:27], 0 offen offset:16
    buffer_load_dwordx4 v[28:31], v14, s[24:27], 0 offen
    buffer_load_dwordx2 v[32:33], v14, s[24:27], 0 offen offset:16
    buffer_load_dwordx2 v[34:35], v15, s[24:27], 0 offen
    ds_read_b64_tr_b16 v[232:233], v3 offset:13056
    ds_read_b64_tr_b16 v[234:235], v3 offset:13464
    ds_read_b64_tr_b16 v[236:237], v3 offset:13064
    ds_read_b64_tr_b16 v[238:239], v3 offset:13472
    ds_read_b64_tr_b16 v[240:241], v3 offset:13072
    ds_read_b64_tr_b16 v[242:243], v3 offset:13480
    ds_read_b64_tr_b16 v[244:245], v9 offset:13056
    ds_read_b64_tr_b16 v[246:247], v9 offset:13464
    s_waitcnt lgkmcnt(15)
    v_mfma_f32_16x16x32_bf16 v[160:163], v[200:203], v[52:55], v[160:163]
    v_mfma_f32_16x16x32_bf16 v[172:175], v[200:203], v[56:59], v[172:175]
    v_mfma_f32_16x16x32_bf16 v[184:187], v[200:203], v[60:63], v[184:187]
    v_mfma_f32_16x16x32_bf16 v[164:167], v[204:207], v[52:55], v[164:167]
    v_mfma_f32_16x16x32_bf16 v[176:179], v[204:207], v[56:59], v[176:179]
    v_mfma_f32_16x16x32_bf16 v[188:191], v[204:207], v[60:63], v[188:191]
    v_mfma_f32_16x16x32_bf16 v[168:171], v[208:211], v[52:55], v[168:171]
    v_mfma_f32_16x16x32_bf16 v[180:183], v[208:211], v[56:59], v[180:183]
    v_mfma_f32_16x16x32_bf16 v[192:195], v[208:211], v[60:63], v[192:195]
    v_mfma_f32_16x16x32_bf16 v[196:199], v[200:203], v[212:215], v[196:199]
    ds_read_b64_tr_b16 v[200:201], v3 offset:26112
    ds_read_b64_tr_b16 v[202:203], v3 offset:26520
    ds_read_b64_tr_b16 v[204:205], v3 offset:26120
    ds_read_b64_tr_b16 v[206:207], v3 offset:26528
    ds_read_b64_tr_b16 v[208:209], v3 offset:26128
    ds_read_b64_tr_b16 v[210:211], v3 offset:26536
    ds_read_b64_tr_b16 v[212:213], v9 offset:26112
    ds_read_b64_tr_b16 v[214:215], v9 offset:26520
    s_waitcnt lgkmcnt(15)
    v_mfma_f32_16x16x32_bf16 v[160:163], v[216:219], v[64:67], v[160:163]
    v_mfma_f32_16x16x32_bf16 v[172:175], v[216:219], v[68:71], v[172:175]
    v_mfma_f32_16x16x32_bf16 v[184:187], v[216:219], v[72:75], v[184:187]
    v_mfma_f32_16x16x32_bf16 v[164:167], v[220:223], v[64:67], v[164:167]
    v_mfma_f32_16x16x32_bf16 v[176:179], v[220:223], v[68:71], v[176:179]
    v_mfma_f32_16x16x32_bf16 v[188:191], v[220:223], v[72:75], v[188:191]
    v_mfma_f32_16x16x32_bf16 v[168:171], v[224:227], v[64:67], v[168:171]
    v_mfma_f32_16x16x32_bf16 v[180:183], v[224:227], v[68:71], v[180:183]
    v_mfma_f32_16x16x32_bf16 v[192:195], v[224:227], v[72:75], v[192:195]
    v_mfma_f32_16x16x32_bf16 v[196:199], v[216:219], v[228:231], v[196:199]
    ds_read_b64_tr_b16 v[216:217], v3 offset:39168
    ds_read_b64_tr_b16 v[218:219], v3 offset:39576
    ds_read_b64_tr_b16 v[220:221], v3 offset:39176
    ds_read_b64_tr_b16 v[222:223], v3 offset:39584
    ds_read_b64_tr_b16 v[224:225], v3 offset:39184
    ds_read_b64_tr_b16 v[226:227], v3 offset:39592
    ds_read_b64_tr_b16 v[228:229], v9 offset:39168
    ds_read_b64_tr_b16 v[230:231], v9 offset:39576
    s_waitcnt lgkmcnt(15)
    v_mfma_f32_16x16x32_bf16 v[160:163], v[232:235], v[76:79], v[160:163]
    v_mfma_f32_16x16x32_bf16 v[172:175], v[232:235], v[80:83], v[172:175]
    v_mfma_f32_16x16x32_bf16 v[184:187], v[232:235], v[84:87], v[184:187]
    v_mfma_f32_16x16x32_bf16 v[164:167], v[236:239], v[76:79], v[164:167]
    v_mfma_f32_16x16x32_bf16 v[176:179], v[236:239], v[80:83], v[176:179]
    v_mfma_f32_16x16x32_bf16 v[188:191], v[236:239], v[84:87], v[188:191]
    v_mfma_f32_16x16x32_bf16 v[168:171], v[240:243], v[76:79], v[168:171]
    v_mfma_f32_16x16x32_bf16 v[180:183], v[240:243], v[80:83], v[180:183]
    v_mfma_f32_16x16x32_bf16 v[192:195], v[240:243], v[84:87], v[192:195]
    v_mfma_f32_16x16x32_bf16 v[196:199], v[232:235], v[244:247], v[196:199]
    ds_read_b64_tr_b16 v[232:233], v4 offset:0
    ds_read_b64_tr_b16 v[234:235], v4 offset:408
    ds_read_b64_tr_b16 v[236:237], v4 offset:8
    ds_read_b64_tr_b16 v[238:239], v4 offset:416
    ds_read_b64_tr_b16 v[240:241], v4 offset:16
    ds_read_b64_tr_b16 v[242:243], v4 offset:424
    ds_read_b64_tr_b16 v[244:245], v10 offset:0
    ds_read_b64_tr_b16 v[246:247], v10 offset:408
    s_waitcnt lgkmcnt(15)
    v_mfma_f32_16x16x32_bf16 v[160:163], v[200:203], v[88:91], v[160:163]
    v_mfma_f32_16x16x32_bf16 v[172:175], v[200:203], v[92:95], v[172:175]
    v_mfma_f32_16x16x32_bf16 v[184:187], v[200:203], v[96:99], v[184:187]
    v_mfma_f32_16x16x32_bf16 v[164:167], v[204:207], v[88:91], v[164:167]
    v_mfma_f32_16x16x32_bf16 v[176:179], v[204:207], v[92:95], v[176:179]
    v_mfma_f32_16x16x32_bf16 v[188:191], v[204:207], v[96:99], v[188:191]
    v_mfma_f32_16x16x32_bf16 v[168:171], v[208:211], v[88:91], v[168:171]
    v_mfma_f32_16x16x32_bf16 v[180:183], v[208:211], v[92:95], v[180:183]
    v_mfma_f32_16x16x32_bf16 v[192:195], v[208:211], v[96:99], v[192:195]
    v_mfma_f32_16x16x32_bf16 v[196:199], v[200:203], v[212:215], v[196:199]
    ds_read_b64_tr_b16 v[200:201], v4 offset:13056
    ds_read_b64_tr_b16 v[202:203], v4 offset:13464
    ds_read_b64_tr_b16 v[204:205], v4 offset:13064
    ds_read_b64_tr_b16 v[206:207], v4 offset:13472
    ds_read_b64_tr_b16 v[208:209], v4 offset:13072
    ds_read_b64_tr_b16 v[210:211], v4 offset:13480
    ds_read_b64_tr_b16 v[212:213], v10 offset:13056
    ds_read_b64_tr_b16 v[214:215], v10 offset:13464
    s_waitcnt lgkmcnt(15)
    v_mfma_f32_16x16x32_bf16 v[160:163], v[216:219], v[100:103], v[160:163]
    v_mfma_f32_16x16x32_bf16 v[172:175], v[216:219], v[104:107], v[172:175]
    v_mfma_f32_16x16x32_bf16 v[184:187], v[216:219], v[108:111], v[184:187]
    v_mfma_f32_16x16x32_bf16 v[164:167], v[220:223], v[100:103], v[164:167]
    v_mfma_f32_16x16x32_bf16 v[176:179], v[220:223], v[104:107], v[176:179]
    v_mfma_f32_16x16x32_bf16 v[188:191], v[220:223], v[108:111], v[188:191]
    v_mfma_f32_16x16x32_bf16 v[168:171], v[224:227], v[100:103], v[168:171]
    v_mfma_f32_16x16x32_bf16 v[180:183], v[224:227], v[104:107], v[180:183]
    v_mfma_f32_16x16x32_bf16 v[192:195], v[224:227], v[108:111], v[192:195]
    v_mfma_f32_16x16x32_bf16 v[196:199], v[216:219], v[228:231], v[196:199]
    ds_read_b64_tr_b16 v[216:217], v4 offset:26112
    ds_read_b64_tr_b16 v[218:219], v4 offset:26520
    ds_read_b64_tr_b16 v[220:221], v4 offset:26120
    ds_read_b64_tr_b16 v[222:223], v4 offset:26528
    ds_read_b64_tr_b16 v[224:225], v4 offset:26128
    ds_read_b64_tr_b16 v[226:227], v4 offset:26536
    ds_read_b64_tr_b16 v[228:229], v10 offset:26112
    ds_read_b64_tr_b16 v[230:231], v10 offset:26520
    s_waitcnt lgkmcnt(15)
    v_mfma_f32_16x16x32_bf16 v[160:163], v[232:235], v[112:115], v[160:163]
    v_mfma_f32_16x16x32_bf16 v[172:175], v[232:235], v[116:119], v[172:175]
    v_mfma_f32_16x16x32_bf16 v[184:187], v[232:235], v[120:123], v[184:187]
    v_mfma_f32_16x16x32_bf16 v[164:167], v[236:239], v[112:115], v[164:167]
    v_mfma_f32_16x16x32_bf16 v[176:179], v[236:239], v[116:119], v[176:179]
    v_mfma_f32_16x16x32_bf16 v[188:191], v[236:239], v[120:123], v[188:191]
    v_mfma_f32_16x16x32_bf16 v[168:171], v[240:243], v[112:115], v[168:171]
    v_mfma_f32_16x16x32_bf16 v[180:183], v[240:243], v[116:119], v[180:183]
    v_mfma_f32_16x16x32_bf16 v[192:195], v[240:243], v[120:123], v[192:195]
    v_mfma_f32_16x16x32_bf16 v[196:199], v[232:235], v[244:247], v[196:199]
    s_waitcnt vmcnt(0)
    v_lshlrev_b32 v40, 16, v16
    v_and_b32 v41, s66, v16
    v_lshlrev_b32 v42, 16, v17
    v_and_b32 v43, s66, v17
    v_lshlrev_b32 v44, 16, v18
    v_and_b32 v45, s66, v18
    v_lshlrev_b32 v46, 16, v19
    v_and_b32 v47, s66, v19
    v_lshlrev_b32 v48, 16, v20
    v_and_b32 v49, s66, v20
    ds_read_b64_tr_b16 v[232:233], v4 offset:39168
    ds_read_b64_tr_b16 v[234:235], v4 offset:39576
    ds_read_b64_tr_b16 v[236:237], v4 offset:39176
    ds_read_b64_tr_b16 v[238:239], v4 offset:39584
    ds_read_b64_tr_b16 v[240:241], v4 offset:39184
    ds_read_b64_tr_b16 v[242:243], v4 offset:39592
    ds_read_b64_tr_b16 v[244:245], v10 offset:39168
    ds_read_b64_tr_b16 v[246:247], v10 offset:39576
    s_waitcnt lgkmcnt(15)
    v_mfma_f32_16x16x32_bf16 v[160:163], v[200:203], v[124:127], v[160:163]
    v_mfma_f32_16x16x32_bf16 v[172:175], v[200:203], v[128:131], v[172:175]
    v_mfma_f32_16x16x32_bf16 v[184:187], v[200:203], v[132:135], v[184:187]
    v_mfma_f32_16x16x32_bf16 v[164:167], v[204:207], v[124:127], v[164:167]
    v_mfma_f32_16x16x32_bf16 v[176:179], v[204:207], v[128:131], v[176:179]
    v_mfma_f32_16x16x32_bf16 v[188:191], v[204:207], v[132:135], v[188:191]
    v_mfma_f32_16x16x32_bf16 v[168:171], v[208:211], v[124:127], v[168:171]
    v_mfma_f32_16x16x32_bf16 v[180:183], v[208:211], v[128:131], v[180:183]
    v_mfma_f32_16x16x32_bf16 v[192:195], v[208:211], v[132:135], v[192:195]
    v_mfma_f32_16x16x32_bf16 v[196:199], v[200:203], v[212:215], v[196:199]
    v_lshlrev_b32 v50, 16, v21
    v_and_b32 v51, s66, v21
    v_lshlrev_b32 v52, 16, v22
    v_and_b32 v53, s66, v22
    v_lshlrev_b32 v54, 16, v23
    v_and_b32 v55, s66, v23
    v_lshlrev_b32 v56, 16, v24
    v_and_b32 v57, s66, v24
    v_lshlrev_b32 v58, 16, v25
    v_and_b32 v59, s66, v25
    s_waitcnt lgkmcnt(8)
    v_mfma_f32_16x16x32_bf16 v[160:163], v[216:219], v[136:139], v[160:163]
    v_mfma_f32_16x16x32_bf16 v[172:175], v[216:219], v[140:143], v[172:175]
    v_mfma_f32_16x16x32_bf16 v[184:187], v[216:219], v[144:147], v[184:187]
    v_mfma_f32_16x16x32_bf16 v[164:167], v[220:223], v[136:139], v[164:167]
    v_mfma_f32_16x16x32_bf16 v[176:179], v[220:223], v[140:143], v[176:179]
    v_mfma_f32_16x16x32_bf16 v[188:191], v[220:223], v[144:147], v[188:191]
    v_mfma_f32_16x16x32_bf16 v[168:171], v[224:227], v[136:139], v[168:171]
    v_mfma_f32_16x16x32_bf16 v[180:183], v[224:227], v[140:143], v[180:183]
    v_mfma_f32_16x16x32_bf16 v[192:195], v[224:227], v[144:147], v[192:195]
    v_mfma_f32_16x16x32_bf16 v[196:199], v[216:219], v[228:231], v[196:199]
    v_lshlrev_b32 v60, 16, v26
    v_and_b32 v61, s66, v26
    v_lshlrev_b32 v62, 16, v27
    v_and_b32 v63, s66, v27
    v_lshlrev_b32 v64, 16, v28
    v_and_b32 v65, s66, v28
    v_lshlrev_b32 v66, 16, v29
    v_and_b32 v67, s66, v29
    v_lshlrev_b32 v68, 16, v30
    v_and_b32 v69, s66, v30
    s_waitcnt lgkmcnt(0)
    v_mfma_f32_16x16x32_bf16 v[160:163], v[232:235], v[148:151], v[160:163]
    v_mfma_f32_16x16x32_bf16 v[172:175], v[232:235], v[152:155], v[172:175]
    v_mfma_f32_16x16x32_bf16 v[184:187], v[232:235], v[156:159], v[184:187]
    v_mfma_f32_16x16x32_bf16 v[164:167], v[236:239], v[148:151], v[164:167]
    v_mfma_f32_16x16x32_bf16 v[176:179], v[236:239], v[152:155], v[176:179]
    v_mfma_f32_16x16x32_bf16 v[188:191], v[236:239], v[156:159], v[188:191]
    v_mfma_f32_16x16x32_bf16 v[168:171], v[240:243], v[148:151], v[168:171]
    v_mfma_f32_16x16x32_bf16 v[180:183], v[240:243], v[152:155], v[180:183]
    v_mfma_f32_16x16x32_bf16 v[192:195], v[240:243], v[156:159], v[192:195]
    v_mfma_f32_16x16x32_bf16 v[196:199], v[232:235], v[244:247], v[196:199]
    v_lshlrev_b32 v70, 16, v31
    v_and_b32 v71, s66, v31
    v_lshlrev_b32 v72, 16, v32
    v_and_b32 v73, s66, v32
    v_lshlrev_b32 v74, 16, v33
    v_and_b32 v75, s66, v33
    v_lshlrev_b32 v76, 16, v34
    v_and_b32 v77, s66, v34
    v_lshlrev_b32 v78, 16, v35
    v_and_b32 v79, s66, v35
    s_branch L_epi
L_g2_1:
    ds_read_b64_tr_b16 v[200:201], v2 offset:0
    ds_read_b64_tr_b16 v[202:203], v2 offset:408
    ds_read_b64_tr_b16 v[204:205], v2 offset:8
    ds_read_b64_tr_b16 v[206:207], v2 offset:416
    ds_read_b64_tr_b16 v[208:209], v2 offset:16
    ds_read_b64_tr_b16 v[210:211], v2 offset:424
    ds_read_b64_tr_b16 v[212:213], v8 offset:0
    ds_read_b64_tr_b16 v[214:215], v8 offset:408
    ds_read_b64_tr_b16 v[216:217], v2 offset:13056
    ds_read_b64_tr_b16 v[218:219], v2 offset:13464
    ds_read_b64_tr_b16 v[220:221], v2 offset:13064
    ds_read_b64_tr_b16 v[222:223], v2 offset:13472
    ds_read_b64_tr_b16 v[224:225], v2 offset:13072
    ds_read_b64_tr_b16 v[226:227], v2 offset:13480
    ds_read_b64_tr_b16 v[228:229], v8 offset:13056
    ds_read_b64_tr_b16 v[230:231], v8 offset:13464
    ds_read_b64_tr_b16 v[232:233], v2 offset:26112
    ds_read_b64_tr_b16 v[234:235], v2 offset:26520
    ds_read_b64_tr_b16 v[236:237], v2 offset:26120
    ds_read_b64_tr_b16 v[238:239], v2 offset:26528
    ds_read_b64_tr_b16 v[240:241], v2 offset:26128
    ds_read_b64_tr_b16 v[242:243], v2 offset:26536
    ds_read_b64_tr_b16 v[244:245], v8 offset:26112
    ds_read_b64_tr_b16 v[246:247], v8 offset:26520
    s_waitcnt lgkmcnt(15)
    v_mfma_f32_16x16x32_bf16 v[160:163], v[200:203], v[16:19], v[160:163]
    v_mfma_f32_16x16x32_bf16 v[172:175], v[200:203], v[20:23], v[172:175]
    v_mfma_f32_16x16x32_bf16 v[184:187], v[200:203], v[24:27], v[184:187]
    v_mfma_f32_16x16x32_bf16 v[164:167], v[204:207], v[16:19], v[164:167]
    v_mfma_f32_16x16x32_bf16 v[176:179], v[204:207], v[20:23], v[176:179]
    v_mfma_f32_16x16x32_bf16 v[188:191], v[204:207], v[24:27], v[188:191]
    v_mfma_f32_16x16x32_bf16 v[168:171], v[208:211], v[16:19], v[168:171]
    v_mfma_f32_16x16x32_bf16 v[180:183], v[208:211], v[20:23], v[180:183]
    v_mfma_f32_16x16x32_bf16 v[192:195], v[208:211], v[24:27], v[192:195]
    v_mfma_f32_16x16x32_bf16 v[196:199], v[204:207], v[212:215], v[196:199]
    ds_read_b64_tr_b16 v[200:201], v2 offset:39168
    ds_read_b64_tr_b16 v[202:203], v2 offset:39576
    ds_read_b64_tr_b16 v[204:205], v2 offset:39176
    ds_read_b64_tr_b16 v[206:207], v2 offset:39584
    ds_read_b64_tr_b16 v[208:209], v2 offset:39184
    ds_read_b64_tr_b16 v[210:211], v2 offset:39592
    ds_read_b64_tr_b16 v[212:213], v8 offset:39168
    ds_read_b64_tr_b16 v[214:215], v8 offset:39576
    s_waitcnt lgkmcnt(15)
    v_mfma_f32_16x16x32_bf16 v[160:163], v[216:219], v[28:31], v[160:163]
    v_mfma_f32_16x16x32_bf16 v[172:175], v[216:219], v[32:35], v[172:175]
    v_mfma_f32_16x16x32_bf16 v[184:187], v[216:219], v[36:39], v[184:187]
    v_mfma_f32_16x16x32_bf16 v[164:167], v[220:223], v[28:31], v[164:167]
    v_mfma_f32_16x16x32_bf16 v[176:179], v[220:223], v[32:35], v[176:179]
    v_mfma_f32_16x16x32_bf16 v[188:191], v[220:223], v[36:39], v[188:191]
    v_mfma_f32_16x16x32_bf16 v[168:171], v[224:227], v[28:31], v[168:171]
    v_mfma_f32_16x16x32_bf16 v[180:183], v[224:227], v[32:35], v[180:183]
    v_mfma_f32_16x16x32_bf16 v[192:195], v[224:227], v[36:39], v[192:195]
    v_mfma_f32_16x16x32_bf16 v[196:199], v[220:223], v[228:231], v[196:199]
    ds_read_b64_tr_b16 v[216:217], v3 offset:0
    ds_read_b64_tr_b16 v[218:219], v3 offset:408
    ds_read_b64_tr_b16 v[220:221], v3 offset:8
    ds_read_b64_tr_b16 v[222:223], v3 offset:416
    ds_read_b64_tr_b16 v[224:225], v3 offset:16
    ds_read_b64_tr_b16 v[226:227], v3 offset:424
    ds_read_b64_tr_b16 v[228:229], v9 offset:0
    ds_read_b64_tr_b16 v[230:231], v9 offset:408
    s_waitcnt lgkmcnt(15)
    v_mfma_f32_16x16x32_bf16 v[160:163], v[232:235], v[40:43], v[160:163]
    v_mfma_f32_16x16x32_bf16 v[172:175], v[232:235], v[44:47], v[172:175]
    v_mfma_f32_16x16x32_bf16 v[184:187], v[232:235], v[48:51], v[184:187]
    v_mfma_f32_16x16x32_bf16 v[164:167], v[236:239], v[40:43], v[164:167]
    v_mfma_f32_16x16x32_bf16 v[176:179], v[236:239], v[44:47], v[176:179]
    v_mfma_f32_16x16x32_bf16 v[188:191], v[236:239], v[48:51], v[188:191]
    v_mfma_f32_16x16x32_bf16 v[168:171], v[240:243], v[40:43], v[168:171]
    v_mfma_f32_16x16x32_bf16 v[180:183], v[240:243], v[44:47], v[180:183]
    v_mfma_f32_16x16x32_bf16 v[192:195], v[240:243], v[48:51], v[192:195]
    v_mfma_f32_16x16x32_bf16 v[196:199], v[236:239], v[244:247], v[196:199]
    buffer_load_dwordx4 v[16:19], v12, s[24:27], 0 offen
    buffer_load_dwordx2 v[20:21], v12, s[24:27], 0 offen offset:16
    buffer_load_dwordx4 v[22:25], v13, s[24:27], 0 offen
    buffer_load_dwordx2 v[26:27], v13, s[24:27], 0 offen offset:16
    buffer_load_dwordx4 v[28:31], v14, s[24:27], 0 offen
    buffer_load_dwordx2 v[32:33], v14, s[24:27], 0 offen offset:16
    buffer_load_dwordx2 v[34:35], v15, s[24:27], 0 offen
    ds_read_b64_tr_b16 v[232:233], v3 offset:13056
    ds_read_b64_tr_b16 v[234:235], v3 offset:13464
    ds_read_b64_tr_b16 v[236:237], v3 offset:13064
    ds_read_b64_tr_b16 v[238:239], v3 offset:13472
    ds_read_b64_tr_b16 v[240:241], v3 offset:13072
    ds_read_b64_tr_b16 v[242:243], v3 offset:13480
    ds_read_b64_tr_b16 v[244:245], v9 offset:13056
    ds_read_b64_tr_b16 v[246:247], v9 offset:13464
    s_waitcnt lgkmcnt(15)
    v_mfma_f32_16x16x32_bf16 v[160:163], v[200:203], v[52:55], v[160:163]
    v_mfma_f32_16x16x32_bf16 v[172:175], v[200:203], v[56:59], v[172:175]
    v_mfma_f32_16x16x32_bf16 v[184:187], v[200:203], v[60:63], v[184:187]
    v_mfma_f32_16x16x32_bf16 v[164:167], v[204:207], v[52:55], v[164:167]
    v_mfma_f32_16x16x32_bf16 v[176:179], v[204:207], v[56:59], v[176:179]
    v_mfma_f32_16x16x32_bf16 v[188:191], v[204:207], v[60:63], v[188:191]
    v_mfma_f32_16x16x32_bf16 v[168:171], v[208:211], v[52:55], v[168:171]
    v_mfma_f32_16x16x32_bf16 v[180:183], v[208:211], v[56:59], v[180:183]
    v_mfma_f32_16x16x32_bf16 v[192:195], v[208:211], v[60:63], v[192:195]
    v_mfma_f32_16x16x32_bf16 v[196:199], v[204:207], v[212:215], v[196:199]
    ds_read_b64_tr_b16 v[200:201], v3 offset:26112
    ds_read_b64_tr_b16 v[202:203], v3 offset:26520
    ds_read_b64_tr_b16 v[204:205], v3 offset:26120
    ds_read_b64_tr_b16 v[206:207], v3 offset:26528
    ds_read_b64_tr_b16 v[208:209], v3 offset:26128
    ds_read_b64_tr_b16 v[210:211], v3 offset:26536
    ds_read_b64_tr_b16 v[212:213], v9 offset:26112
    ds_read_b64_tr_b16 v[214:215], v9 offset:26520
    s_waitcnt lgkmcnt(15)
    v_mfma_f32_16x16x32_bf16 v[160:163], v[216:219], v[64:67], v[160:163]
    v_mfma_f32_16x16x32_bf16 v[172:175], v[216:219], v[68:71], v[172:175]
    v_mfma_f32_16x16x32_bf16 v[184:187], v[216:219], v[72:75], v[184:187]
    v_mfma_f32_16x16x32_bf16 v[164:167], v[220:223], v[64:67], v[164:167]
    v_mfma_f32_16x16x32_bf16 v[176:179], v[220:223], v[68:71], v[176:179]
    v_mfma_f32_16x16x32_bf16 v[188:191], v[220:223], v[72:75], v[188:191]
    v_mfma_f32_16x16x32_bf16 v[168:171], v[224:227], v[64:67], v[168:171]
    v_mfma_f32_16x16x32_bf16 v[180:183], v[224:227], v[68:71], v[180:183]
    v_mfma_f32_16x16x32_bf16 v[192:195], v[224:227], v[72:75], v[192:195]
    v_mfma_f32_16x16x32_bf16 v[196:199], v[220:223], v[228:231], v[196:199]
    ds_read_b64_tr_b16 v[216:217], v3 offset:39168
    ds_read_b64_tr_b16 v[218:219], v3 offset:39576
    ds_read_b64_tr_b16 v[220:221], v3 offset:39176
    ds_read_b64_tr_b16 v[222:223], v3 offset:39584
    ds_read_b64_tr_b16 v[224:225], v3 offset:39184
    ds_read_b64_tr_b16 v[226:227], v3 offset:39592
    ds_read_b64_tr_b16 v[228:229], v9 offset:39168
    ds_read_b64_tr_b16 v[230:231], v9 offset:39576
    s_waitcnt lgkmcnt(15)
    v_mfma_f32_16x16x32_bf16 v[160:163], v[232:235], v[76:79], v[160:163]
    v_mfma_f32_16x16x32_bf16 v[172:175], v[232:235], v[80:83], v[172:175]
    v_mfma_f32_16x16x32_bf16 v[184:187], v[232:235], v[84:87], v[184:187]
    v_mfma_f32_16x16x32_bf16 v[164:167], v[236:239], v[76:79], v[164:167]
    v_mfma_f32_16x16x32_bf16 v[176:179], v[236:239], v[80:83], v[176:179]
    v_mfma_f32_16x16x32_bf16 v[188:191], v[236:239], v[84:87], v[188:191]
    v_mfma_f32_16x16x32_bf16 v[168:171], v[240:243], v[76:79], v[168:171]
    v_mfma_f32_16x16x32_bf16 v[180:183], v[240:243], v[80:83], v[180:183]
    v_mfma_f32_16x16x32_bf16 v[192:195], v[240:243], v[84:87], v[192:195]
    v_mfma_f32_16x16x32_bf16 v[196:199], v[236:239], v[244:247], v[196:199]
    ds_read_b64_tr_b16 v[232:233], v4 offset:0
    ds_read_b64_tr_b16 v[234:235], v4 offset:408
    ds_read_b64_tr_b16 v[236:237], v4 offset:8
    ds_read_b64_tr_b16 v[238:239], v4 offset:416
    ds_read_b64_tr_b16 v[240:241], v4 offset:16
    ds_read_b64_tr_b16 v[242:243], v4 offset:424
    ds_read_b64_tr_b16 v[244:245], v10 offset:0
    ds_read_b64_tr_b16 v[246:247], v10 offset:408
    s_waitcnt lgkmcnt(15)
    v_mfma_f32_16x16x32_bf16 v[160:163], v[200:203], v[88:91], v[160:163]
    v_mfma_f32_16x16x32_bf16 v[172:175], v[200:203], v[92:95], v[172:175]
    v_mfma_f32_16x16x32_bf16 v[184:187], v[200:203], v[96:99], v[184:187]
    v_mfma_f32_16x16x32_bf16 v[164:167], v[204:207], v[88:91], v[164:167]
    v_mfma_f32_16x16x32_bf16 v[176:179], v[204:207], v[92:95], v[176:179]
    v_mfma_f32_16x16x32_bf16 v[188:191], v[204:207], v[96:99], v[188:191]
    v_mfma_f32_16x16x32_bf16 v[168:171], v[208:211], v[88:91], v[168:171]
    v_mfma_f32_16x16x32_bf16 v[180:183], v[208:211], v[92:95], v[180:183]
    v_mfma_f32_16x16x32_bf16 v[192:195], v[208:211], v[96:99], v[192:195]
    v_mfma_f32_16x16x32_bf16 v[196:199], v[204:207], v[212:215], v[196:199]
    ds_read_b64_tr_b16 v[200:201], v4 offset:13056
    ds_read_b64_tr_b16 v[202:203], v4 offset:13464
    ds_read_b64_tr_b16 v[204:205], v4 offset:13064
    ds_read_b64_tr_b16 v[206:207], v4 offset:13472
    ds_read_b64_tr_b16 v[208:209], v4 offset:13072
    ds_read_b64_tr_b16 v[210:211], v4 offset:13480
    ds_read_b64_tr_b16 v[212:213], v10 offset:13056
    ds_read_b64_tr_b16 v[214:215], v10 offset:13464
    s_waitcnt lgkmcnt(15)
    v_mfma_f32_16x16x32_bf16 v[160:163], v[216:219], v[100:103], v[160:163]
    v_mfma_f32_16x16x32_bf16 v[172:175], v[216:219], v[104:107], v[172:175]
    v_mfma_f32_16x16x32_bf16 v[184:187], v[216:219], v[108:111], v[184:187]
    v_mfma_f32_16x16x32_bf16 v[164:167], v[220:223], v[100:103], v[164:167]
    v_mfma_f32_16x16x32_bf16 v[176:179], v[220:223], v[104:107], v[176:179]
    v_mfma_f32_16x16x32_bf16 v[188:191], v[220:223], v[108:111], v[188:191]
    v_mfma_f32_16x16x32_bf16 v[168:171], v[224:227], v[100:103], v[168:171]
    v_mfma_f32_16x16x32_bf16 v[180:183], v[224:227], v[104:107], v[180:183]
    v_mfma_f32_16x16x32_bf16 v[192:195], v[224:227], v[108:111], v[192:195]
    v_mfma_f32_16x16x32_bf16 v[196:199], v[220:223], v[228:231], v[196:199]
    ds_read_b64_tr_b16 v[216:217], v4 offset:26112
    ds_read_b64_tr_b16 v[218:219], v4 offset:26520
    ds_read_b64_tr_b16 v[220:221], v4 offset:26120
    ds_read_b64_tr_b16 v[222:223], v4 offset:26528
    ds_read_b64_tr_b16 v[224:225], v4 offset:26128
    ds_read_b64_tr_b16 v[226:227], v4 offset:26536
    ds_read_b64_tr_b16 v[228:229], v10 offset:26112
    ds_read_b64_tr_b16 v[230:231], v10 offset:26520
    s_waitcnt lgkmcnt(15)
    v_mfma_f32_16x16x32_bf16 v[160:163], v[232:235], v[112:115], v[160:163]
    v_mfma_f32_16x16x32_bf16 v[172:175], v[232:235], v[116:119], v[172:175]
    v_mfma_f32_16x16x32_bf16 v[184:187], v[232:235], v[120:123], v[184:187]
    v_mfma_f32_16x16x32_bf16 v[164:167], v[236:239], v[112:115], v[164:167]
    v_mfma_f32_16x16x32_bf16 v[176:179], v[236:239], v[116:119], v[176:179]
    v_mfma_f32_16x16x32_bf16 v[188:191], v[236:239], v[120:123], v[188:191]
    v_mfma_f32_16x16x32_bf16 v[168:171], v[240:243], v[112:115], v[168:171]
    v_mfma_f32_16x16x32_bf16 v[180:183], v[240:243], v[116:119], v[180:183]
    v_mfma_f32_16x16x32_bf16 v[192:195], v[240:243], v[120:123], v[192:195]
    v_mfma_f32_16x16x32_bf16 v[196:199], v[236:239], v[244:247], v[196:199]
    s_waitcnt vmcnt(0)
    v_lshlrev_b32 v40, 16, v16
    v_and_b32 v41, s66, v16
    v_lshlrev_b32 v42, 16, v17
    v_and_b32 v43, s66, v17
    v_lshlrev_b32 v44, 16, v18
    v_and_b32 v45, s66, v18
    v_lshlrev_b32 v46, 16, v19
    v_and_b32 v47, s66, v19
    v_lshlrev_b32 v48, 16, v20
    v_and_b32 v49, s66, v20
    ds_read_b64_tr_b16 v[232:233], v4 offset:39168
    ds_read_b64_tr_b16 v[234:235], v4 offset:39576
    ds_read_b64_tr_b16 v[236:237], v4 offset:39176
    ds_read_b64_tr_b16 v[238:239], v4 offset:39584
    ds_read_b64_tr_b16 v[240:241], v4 offset:39184
    ds_read_b64_tr_b16 v[242:243], v4 offset:39592
    ds_read_b64_tr_b16 v[244:245], v10 offset:39168
    ds_read_b64_tr_b16 v[246:247], v10 offset:39576
    s_waitcnt lgkmcnt(15)
    v_mfma_f32_16x16x32_bf16 v[160:163], v[200:203], v[124:127], v[160:163]
    v_mfma_f32_16x16x32_bf16 v[172:175], v[200:203], v[128:131], v[172:175]
    v_mfma_f32_16x16x32_bf16 v[184:187], v[200:203], v[132:135], v[184:187]
    v_mfma_f32_16x16x32_bf16 v[164:167], v[204:207], v[124:127], v[164:167]
    v_mfma_f32_16x16x32_bf16 v[176:179], v[204:207], v[128:131], v[176:179]
    v_mfma_f32_16x16x32_bf16 v[188:191], v[204:207], v[132:135], v[188:191]
    v_mfma_f32_16x16x32_bf16 v[168:171], v[208:211], v[124:127], v[168:171]
    v_mfma_f32_16x16x32_bf16 v[180:183], v[208:211], v[128:131], v[180:183]
    v_mfma_f32_16x16x32_bf16 v[192:195], v[208:211], v[132:135], v[192:195]
    v_mfma_f32_16x16x32_bf16 v[196:199], v[204:207], v[212:215], v[196:199]
    v_lshlrev_b32 v50, 16, v21
    v_and_b32 v51, s66, v21
    v_lshlrev_b32 v52, 16, v22
    v_and_b32 v53, s66, v22
    v_lshlrev_b32 v54, 16, v23
    v_and_b32 v55, s66, v23
    v_lshlrev_b32 v56, 16, v24
    v_and_b32 v57, s66, v24
    v_lshlrev_b32 v58, 16, v25
    v_and_b32 v59, s66, v25
    s_waitcnt lgkmcnt(8)
    v_mfma_f32_16x16x32_bf16 v[160:163], v[216:219], v[136:139], v[160:163]
    v_mfma_f32_16x16x32_bf16 v[172:175], v[216:219], v[140:143], v[172:175]
    v_mfma_f32_16x16x32_bf16 v[184:187], v[216:219], v[144:147], v[184:187]
    v_mfma_f32_16x16x32_bf16 v[164:167], v[220:223], v[136:139], v[164:167]
    v_mfma_f32_16x16x32_bf16 v[176:179], v[220:223], v[140:143], v[176:179]
    v_mfma_f32_16x16x32_bf16 v[188:191], v[220:223], v[144:147], v[188:191]
    v_mfma_f32_16x16x32_bf16 v[168:171], v[224:227], v[136:139], v[168:171]
    v_mfma_f32_16x16x32_bf16 v[180:183], v[224:227], v[140:143], v[180:183]
    v_mfma_f32_16x16x32_bf16 v[192:195], v[224:227], v[144:147], v[192:195]
    v_mfma_f32_16x16x32_bf16 v[196:199], v[220:223], v[228:231], v[196:199]
    v_lshlrev_b32 v60, 16, v26
    v_and_b32 v61, s66, v26
    v_lshlrev_b32 v62, 16, v27
    v_and_b32 v63, s66, v27
    v_lshlrev_b32 v64, 16, v28
    v_and_b32 v65, s66, v28
    v_lshlrev_b32 v66, 16, v29
    v_and_b32 v67, s66, v29
    v_lshlrev_b32 v68, 16, v30
    v_and_b32 v69, s66, v30
    s_waitcnt lgkmcnt(0)
    v_mfma_f32_16x16x32_bf16 v[160:163], v[232:235], v[148:151], v[160:163]
    v_mfma_f32_16x16x32_bf16 v[172:175], v[232:235], v[152:155], v[172:175]
    v_mfma_f32_16x16x32_bf16 v[184:187], v[232:235], v[156:159], v[184:187]
    v_mfma_f32_16x16x32_bf16 v[164:167], v[236:239], v[148:151], v[164:167]
    v_mfma_f32_16x16x32_bf16 v[176:179], v[236:239], v[152:155], v[176:179]
    v_mfma_f32_16x16x32_bf16 v[188:191], v[236:239], v[156:159], v[188:191]
    v_mfma_f32_16x16x32_bf16 v[168:171], v[240:243], v[148:151], v[168:171]
    v_mfma_f32_16x16x32_bf16 v[180:183], v[240:243], v[152:155], v[180:183]
    v_mfma_f32_16x16x32_bf16 v[192:195], v[240:243], v[156:159], v[192:195]
    v_mfma_f32_16x16x32_bf16 v[196:199], v[236:239], v[244:247], v[196:199]
    v_lshlrev_b32 v70, 16, v31
    v_and_b32 v71, s66, v31
    v_lshlrev_b32 v72, 16, v32
    v_and_b32 v73, s66, v32
    v_lshlrev_b32 v74, 16, v33
    v_and_b32 v75, s66, v33
    v_lshlrev_b32 v76, 16, v34
    v_and_b32 v77, s66, v34
    v_lshlrev_b32 v78, 16, v35
    v_and_b32 v79, s66, v35
    s_branch L_epi
L_g2_2:
    ds_read_b64_tr_b16 v[200:201], v2 offset:0
    ds_read_b64_tr_b16 v[202:203], v2 offset:408
    ds_read_b64_tr_b16 v[204:205], v2 offset:8
    ds_read_b64_tr_b16 v[206:207], v2 offset:416
    ds_read_b64_tr_b16 v[208:209], v2 offset:16
    ds_read_b64_tr_b16 v[210:211], v2 offset:424
    ds_read_b64_tr_b16 v[212:213], v8 offset:0
    ds_read_b64_tr_b16 v[214:215], v8 offset:408
    ds_read_b64_tr_b16 v[216:217], v2 offset:13056
    ds_read_b64_tr_b16 v[218:219], v2 offset:13464
    ds_read_b64_tr_b16 v[220:221], v2 offset:13064
    ds_read_b64_tr_b16 v[222:223], v2 offset:13472
    ds_read_b64_tr_b16 v[224:225], v2 offset:13072
    ds_read_b64_tr_b16 v[226:227], v2 offset:13480
    ds_read_b64_tr_b16 v[228:229], v8 offset:13056
    ds_read_b64_tr_b16 v[230:231], v8 offset:13464
    ds_read_b64_tr_b16 v[232:233], v2 offset:26112
    ds_read_b64_tr_b16 v[234:235], v2 offset:26520
    ds_read_b64_tr_b16 v[236:237], v2 offset:26120
    ds_read_b64_tr_b16 v[238:239], v2 offset:26528
    ds_read_b64_tr_b16 v[240:241], v2 offset:26128
    ds_read_b64_tr_b16 v[242:243], v2 offset:26536
    ds_read_b64_tr_b16 v[244:245], v8 offset:26112
    ds_read_b64_tr_b16 v[246:247], v8 offset:26520
    s_waitcnt lgkmcnt(15)
    v_mfma_f32_16x16x32_bf16 v[160:163], v[200:203], v[16:19], v[160:163]
    v_mfma_f32_16x16x32_bf16 v[172:175], v[200:203], v[20:23], v[172:175]
    v_mfma_f32_16x16x32_bf16 v[184:187], v[200:203], v[24:27], v[184:187]
    v_mfma_f32_16x16x32_bf16 v[164:167], v[204:207], v[16:19], v[164:167]
    v_mfma_f32_16x16x32_bf16 v[176:179], v[204:207], v[20:23], v[176:179]
    v_mfma_f32_16x16x32_bf16 v[188:191], v[204:207], v[24:27], v[188:191]
    v_mfma_f32_16x16x32_bf16 v[168:171], v[208:211], v[16:19], v[168:171]
    v_mfma_f32_16x16x32_bf16 v[180:183], v[208:211], v[20:23], v[180:183]
    v_mfma_f32_16x16x32_bf16 v[192:195], v[208:211], v[24:27], v[192:195]
    v_mfma_f32_16x16x32_bf16 v[196:199], v[208:211], v[212:215], v[196:199]
    ds_read_b64_tr_b16 v[200:201], v2 offset:39168
    ds_read_b64_tr_b16 v[202:203], v2 offset:39576
    ds_read_b64_tr_b16 v[204:205], v2 offset:39176
    ds_read_b64_tr_b16 v[206:207], v2 offset:39584
    ds_read_b64_tr_b16 v[208:209], v2 offset:39184
    ds_read_b64_tr_b16 v[210:211], v2 offset:39592
    ds_read_b64_tr_b16 v[212:213], v8 offset:39168
    ds_read_b64_tr_b16 v[214:215], v8 offset:39576
    s_waitcnt lgkmcnt(15)
    v_mfma_f32_16x16x32_bf16 v[160:163], v[216:219], v[28:31], v[160:163]
    v_mfma_f32_16x16x32_bf16 v[172:175], v[216:219], v[32:35], v[172:175]
    v_mfma_f32_16x16x32_bf16 v[184:187], v[216:219], v[36:39], v[184:187]
    v_mfma_f32_16x16x32_bf16 v[164:167], v[220:223], v[28:31], v[164:167]
    v_mfma_f32_16x16x32_bf16 v[176:179], v[220:223], v[32:35], v[176:179]
    v_mfma_f32_16x16x32_bf16 v[188:191], v[220:223], v[36:39], v[188:191]
    v_mfma_f32_16x16x32_bf16 v[168:171], v[224:227], v[28:31], v[168:171]
    v_mfma_f32_16x16x32_bf16 v[180:183], v[224:227], v[32:35], v[180:183]
    v_mfma_f32_16x16x32_bf16 v[192:195], v[224:227], v[36:39], v[192:195]
    v_mfma_f32_16x16x32_bf16 v[196:199], v[224:227], v[228:231], v[196:199]
    ds_read_b64_tr_b16 v[216:217], v3 offset:0
    ds_read_b64_tr_b16 v[218:219], v3 offset:408
    ds_read_b64_tr_b16 v[220:221], v3 offset:8
    ds_read_b64_tr_b16 v[222:223], v3 offset:416
    ds_read_b64_tr_b16 v[224:225], v3 offset:16
    ds_read_b64_tr_b16 v[226:227], v3 offset:424
    ds_read_b64_tr_b16 v[228:229], v9 offset:0
    ds_read_b64_tr_b16 v[230:231], v9 offset:408
    s_waitcnt lgkmcnt(15)
    v_mfma_f32_16x16x32_bf16 v[160:163], v[232:235], v[40:43], v[160:163]
    v_mfma_f32_16x16x32_bf16 v[172:175], v[232:235], v[44:47], v[172:175]
    v_mfma_f32_16x16x32_bf16 v[184:187], v[232:235], v[48:51], v[184:187]
    v_mfma_f32_16x16x32_bf16 v[164:167], v[236:239], v[40:43], v[164:167]
    v_mfma_f32_16x16x32_bf16 v[176:179], v[236:239], v[44:47], v[176:179]
    v_mfma_f32_16x16x32_bf16 v[188:191], v[236:239], v[48:51], v[188:191]
    v_mfma_f32_16x16x32_bf16 v[168:171], v[240:243], v[40:43], v[168:171]
    v_mfma_f32_16x16x32_bf16 v[180:183], v[240:243], v[44:47], v[180:183]
    v_mfma_f32_16x16x32_bf16 v[192:195], v[240:243], v[48:51], v[192:195]
    v_mfma_f32_16x16x32_bf16 v[196:199], v[240:243], v[244:247], v[196:199]
    buffer_load_dwordx4 v[16:19], v12, s[24:27], 0 offen
    buffer_load_dwordx2 v[20:21], v12, s[24:27], 0 offen offset:16
    buffer_load_dwordx4 v[22:25], v13, s[24:27], 0 offen
    buffer_load_dwordx2 v[26:27], v13, s[24:27], 0 offen offset:16
    buffer_load_dwordx4 v[28:31], v14, s[24:27], 0 offen
    buffer_load_dwordx2 v[32:33], v14, s[24:27], 0 offen offset:16
    buffer_load_dwordx2 v[34:35], v15, s[24:27], 0 offen
    ds_read_b64_tr_b16 v[232:233], v3 offset:13056
    ds_read_b64_tr_b16 v[234:235], v3 offset:13464
    ds_read_b64_tr_b16 v[236:237], v3 offset:13064
    ds_read_b64_tr_b16 v[238:239], v3 offset:13472
    ds_read_b64_tr_b16 v[240:241], v3 offset:13072
    ds_read_b64_tr_b16 v[242:243], v3 offset:13480
    ds_read_b64_tr_b16 v[244:245], v9 offset:13056
    ds_read_b64_tr_b16 v[246:247], v9 offset:13464
    s_waitcnt lgkmcnt(15)
    v_mfma_f32_16x16x32_bf16 v[160:163], v[200:203], v[52:55], v[160:163]
    v_mfma_f32_16x16x32_bf16 v[172:175], v[200:203], v[56:59], v[172:175]
    v_mfma_f32_16x16x32_bf16 v[184:187], v[200:203], v[60:63], v[184:187]
    v_mfma_f32_16x16x32_bf16 v[164:167], v[204:207], v[52:55], v[164:167]
    v_mfma_f32_16x16x32_bf16 v[176:179], v[204:207], v[56:59], v[176:179]
    v_mfma_f32_16x16x32_bf16 v[188:191], v[204:207], v[60:63], v[188:191]
    v_mfma_f32_16x16x32_bf16 v[168:171], v[208:211], v[52:55], v[168:171]
    v_mfma_f32_16x16x32_bf16 v[180:183], v[208:211], v[56:59], v[180:183]
    v_mfma_f32_16x16x32_bf16 v[192:195], v[208:211], v[60:63], v[192:195]
    v_mfma_f32_16x16x32_bf16 v[196:199], v[208:211], v[212:215], v[196:199]
    ds_read_b64_tr_b16 v[200:201], v3 offset:26112
    ds_read_b64_tr_b16 v[202:203], v3 offset:26520
    ds_read_b64_tr_b16 v[204:205], v3 offset:26120
    ds_read_b64_tr_b16 v[206:207], v3 offset:26528
    ds_read_b64_tr_b16 v[208:209], v3 offset:26128
    ds_read_b64_tr_b16 v[210:211], v3 offset:26536
    ds_read_b64_tr_b16 v[212:213], v9 offset:26112
    ds_read_b64_tr_b16 v[214:215], v9 offset:26520
    s_waitcnt lgkmcnt(15)
    v_mfma_f32_16x16x32_bf16 v[160:163], v[216:219], v[64:67], v[160:163]
    v_mfma_f32_16x16x32_bf16 v[172:175], v[216:219], v[68:71], v[172:175]
    v_mfma_f32_16x16x32_bf16 v[184:187], v[216:219], v[72:75], v[184:187]
    v_mfma_f32_16x16x32_bf16 v[164:167], v[220:223], v[64:67], v[164:167]
    v_mfma_f32_16x16x32_bf16 v[176:179], v[220:223], v[68:71], v[176:179]
    v_mfma_f32_16x16x32_bf16 v[188:191], v[220:223], v[72:75], v[188:191]
    v_mfma_f32_16x16x32_bf16 v[168:171], v[224:227], v[64:67], v[168:171]
    v_mfma_f32_16x16x32_bf16 v[180:183], v[224:227], v[68:71], v[180:183]
    v_mfma_f32_16x16x32_bf16 v[192:195], v[224:227], v[72:75], v[192:195]
    v_mfma_f32_16x16x32_bf16 v[196:199], v[224:227], v[228:231], v[196:199]
    ds_read_b64_tr_b16 v[216:217], v3 offset:39168
    ds_read_b64_tr_b16 v[218:219], v3 offset:39576
    ds_read_b64_tr_b16 v[220:221], v3 offset:39176
    ds_read_b64_tr_b16 v[222:223], v3 offset:39584
    ds_read_b64_tr_b16 v[224:225], v3 offset:39184
    ds_read_b64_tr_b16 v[226:227], v3 offset:39592
    ds_read_b64_tr_b16 v[228:229], v9 offset:39168
    ds_read_b64_tr_b16 v[230:231], v9 offset:39576
    s_waitcnt lgkmcnt(15)
    v_mfma_f32_16x16x32_bf16 v[160:163], v[232:235], v[76:79], v[160:163]
    v_mfma_f32_16x16x32_bf16 v[172:175], v[232:235], v[80:83], v[172:175]
    v_mfma_f32_16x16x32_bf16 v[184:187], v[232:235], v[84:87], v[184:187]
    v_mfma_f32_16x16x32_bf16 v[164:167], v[236:239], v[76:79], v[164:167]
    v_mfma_f32_16x16x32_bf16 v[176:179], v[236:239], v[80:83], v[176:179]
    v_mfma_f32_16x16x32_bf16 v[188:191], v[236:239], v[84:87], v[188:191]
    v_mfma_f32_16x16x32_bf16 v[168:171], v[240:243], v[76:79], v[168:171]
    v_mfma_f32_16x16x32_bf16 v[180:183], v[240:243], v[80:83], v[180:183]
    v_mfma_f32_16x16x32_bf16 v[192:195], v[240:243], v[84:87], v[192:195]
    v_mfma_f32_16x16x32_bf16 v[196:199], v[240:243], v[244:247], v[196:199]
    ds_read_b64_tr_b16 v[232:233], v4 offset:0
    ds_read_b64_tr_b16 v[234:235], v4 offset:408
    ds_read_b64_tr_b16 v[236:237], v4 offset:8
    ds_read_b64_tr_b16 v[238:239], v4 offset:416
    ds_read_b64_tr_b16 v[240:241], v4 offset:16
    ds_read_b64_tr_b16 v[242:243], v4 offset:424
    ds_read_b64_tr_b16 v[244:245], v10 offset:0
    ds_read_b64_tr_b16 v[246:247], v10 offset:408
    s_waitcnt lgkmcnt(15)
    v_mfma_f32_16x16x32_bf16 v[160:163], v[200:203], v[88:91], v[160:163]
    v_mfma_f32_16x16x32_bf16 v[172:175], v[200:203], v[92:95], v[172:175]
    v_mfma_f32_16x16x32_bf16 v[184:187], v[200:203], v[96:99], v[184:187]
    v_mfma_f32_16x16x32_bf16 v[164:167], v[204:207], v[88:91], v[164:167]
    v_mfma_f32_16x16x32_bf16 v[176:179], v[204:207], v[92:95], v[176:179]
    v_mfma_f32_16x16x32_bf16 v[188:191], v[204:207], v[96:99], v[188:191]
    v_mfma_f32_16x16x32_bf16 v[168:171], v[208:211], v[88:91], v[168:171]
    v_mfma_f32_16x16x32_bf16 v[180:183], v[208:211], v[92:95], v[180:183]
    v_mfma_f32_16x16x32_bf16 v[192:195], v[208:211], v[96:99], v[192:195]
    v_mfma_f32_16x16x32_bf16 v[196:199], v[208:211], v[212:215], v[196:199]
    ds_read_b64_tr_b16 v[200:201], v4 offset:13056
    ds_read_b64_tr_b16 v[202:203], v4 offset:13464
    ds_read_b64_tr_b16 v[204:205], v4 offset:13064
    ds_read_b64_tr_b16 v[206:207], v4 offset:13472
    ds_read_b64_tr_b16 v[208:209], v4 offset:13072
    ds_read_b64_tr_b16 v[210:211], v4 offset:13480
    ds_read_b64_tr_b16 v[212:213], v10 offset:13056
    ds_read_b64_tr_b16 v[214:215], v10 offset:13464
    s_waitcnt lgkmcnt(15)
    v_mfma_f32_16x16x32_bf16 v[160:163], v[216:219], v[100:103], v[160:163]
    v_mfma_f32_16x16x32_bf16 v[172:175], v[216:219], v[104:107], v[172:175]
    v_mfma_f32_16x16x32_bf16 v[184:187], v[216:219], v[108:111], v[184:187]
    v_mfma_f32_16x16x32_bf16 v[164:167], v[220:223], v[100:103], v[164:167]
    v_mfma_f32_16x16x32_bf16 v[176:179], v[220:223], v[104:107], v[176:179]
    v_mfma_f32_16x16x32_bf16 v[188:191], v[220:223], v[108:111], v[188:191]
    v_mfma_f32_16x16x32_bf16 v[168:171], v[224:227], v[100:103], v[168:171]
    v_mfma_f32_16x16x32_bf16 v[180:183], v[224:227], v[104:107], v[180:183]
    v_mfma_f32_16x16x32_bf16 v[192:195], v[224:227], v[108:111], v[192:195]
    v_mfma_f32_16x16x32_bf16 v[196:199], v[224:227], v[228:231], v[196:199]
    ds_read_b64_tr_b16 v[216:217], v4 offset:26112
    ds_read_b64_tr_b16 v[218:219], v4 offset:26520
    ds_read_b64_tr_b16 v[220:221], v4 offset:26120
    ds_read_b64_tr_b16 v[222:223], v4 offset:26528
    ds_read_b64_tr_b16 v[224:225], v4 offset:26128
    ds_read_b64_tr_b16 v[226:227], v4 offset:26536
    ds_read_b64_tr_b16 v[228:229], v10 offset:26112
    ds_read_b64_tr_b16 v[230:231], v10 offset:26520
    s_waitcnt lgkmcnt(15)
    v_mfma_f32_16x16x32_bf16 v[160:163], v[232:235], v[112:115], v[160:163]
    v_mfma_f32_16x16x32_bf16 v[172:175], v[232:235], v[116:119], v[172:175]
    v_mfma_f32_16x16x32_bf16 v[184:187], v[232:235], v[120:123], v[184:187]
    v_mfma_f32_16x16x32_bf16 v[164:167], v[236:239], v[112:115], v[164:167]
    v_mfma_f32_16x16x32_bf16 v[176:179], v[236:239], v[116:119], v[176:179]
    v_mfma_f32_16x16x32_bf16 v[188:191], v[236:239], v[120:123], v[188:191]
    v_mfma_f32_16x16x32_bf16 v[168:171], v[240:243], v[112:115], v[168:171]
    v_mfma_f32_16x16x32_bf16 v[180:183], v[240:243], v[116:119], v[180:183]
    v_mfma_f32_16x16x32_bf16 v[192:195], v[240:243], v[120:123], v[192:195]
    v_mfma_f32_16x16x32_bf16 v[196:199], v[240:243], v[244:247], v[196:199]
    s_waitcnt vmcnt(0)
    v_lshlrev_b32 v40, 16, v16
    v_and_b32 v41, s66, v16
    v_lshlrev_b32 v42, 16, v17
    v_and_b32 v43, s66, v17
    v_lshlrev_b32 v44, 16, v18
    v_and_b32 v45, s66, v18
    v_lshlrev_b32 v46, 16, v19
    v_and_b32 v47, s66, v19
    v_lshlrev_b32 v48, 16, v20
    v_and_b32 v49, s66, v20
    ds_read_b64_tr_b16 v[232:233], v4 offset:39168
    ds_read_b64_tr_b16 v[234:235], v4 offset:39576
    ds_read_b64_tr_b16 v[236:237], v4 offset:39176
    ds_read_b64_tr_b16 v[238:239], v4 offset:39584
    ds_read_b64_tr_b16 v[240:241], v4 offset:39184
    ds_read_b64_tr_b16 v[242:243], v4 offset:39592
    ds_read_b64_tr_b16 v[244:245], v10 offset:39168
    ds_read_b64_tr_b16 v[246:247], v10 offset:39576
    s_waitcnt lgkmcnt(15)
    v_mfma_f32_16x16x32_bf16 v[160:163], v[200:203], v[124:127], v[160:163]
    v_mfma_f32_16x16x32_bf16 v[172:175], v[200:203], v[128:131], v[172:175]
    v_mfma_f32_16x16x32_bf16 v[184:187], v[200:203], v[132:135], v[184:187]
    v_mfma_f32_16x16x32_bf16 v[164:167], v[204:207], v[124:127], v[164:167]
    v_mfma_f32_16x16x32_bf16 v[176:179], v[204:207], v[128:131], v[176:179]
    v_mfma_f32_16x16x32_bf16 v[188:191], v[204:207], v[132:135], v[188:191]
    v_mfma_f32_16x16x32_bf16 v[168:171], v[208:211], v[124:127], v[168:171]
    v_mfma_f32_16x16x32_bf16 v[180:183], v[208:211], v[128:131], v[180:183]
    v_mfma_f32_16x16x32_bf16 v[192:195], v[208:211], v[132:135], v[192:195]
    v_mfma_f32_16x16x32_bf16 v[196:199], v[208:211], v[212:215], v[196:199]
    v_lshlrev_b32 v50, 16, v21
    v_and_b32 v51, s66, v21
    v_lshlrev_b32 v52, 16, v22
    v_and_b32 v53, s66, v22
    v_lshlrev_b32 v54, 16, v23
    v_and_b32 v55, s66, v23
    v_lshlrev_b32 v56, 16, v24
    v_and_b32 v57, s66, v24
    v_lshlrev_b32 v58, 16, v25
    v_and_b32 v59, s66, v25
    s_waitcnt lgkmcnt(8)
    v_mfma_f32_16x16x32_bf16 v[160:163], v[216:219], v[136:139], v[160:163]
    v_mfma_f32_16x16x32_bf16 v[172:175], v[216:219], v[140:143], v[172:175]
    v_mfma_f32_16x16x32_bf16 v[184:187], v[216:219], v[144:147], v[184:187]
    v_mfma_f32_16x16x32_bf16 v[164:167], v[220:223], v[136:139], v[164:167]
    v_mfma_f32_16x16x32_bf16 v[176:179], v[220:223], v[140:143], v[176:179]
    v_mfma_f32_16x16x32_bf16 v[188:191], v[220:223], v[144:147], v[188:191]
    v_mfma_f32_16x16x32_bf16 v[168:171], v[224:227], v[136:139], v[168:171]
    v_mfma_f32_16x16x32_bf16 v[180:183], v[224:227], v[140:143], v[180:183]
    v_mfma_f32_16x16x32_bf16 v[192:195], v[224:227], v[144:147], v[192:195]
    v_mfma_f32_16x16x32_bf16 v[196:199], v[224:227], v[228:231], v[196:199]
    v_lshlrev_b32 v60, 16, v26
    v_and_b32 v61, s66, v26
    v_lshlrev_b32 v62, 16, v27
    v_and_b32 v63, s66, v27
    v_lshlrev_b32 v64, 16, v28
    v_and_b32 v65, s66, v28
    v_lshlrev_b32 v66, 16, v29
    v_and_b32 v67, s66, v29
    v_lshlrev_b32 v68, 16, v30
    v_and_b32 v69, s66, v30
    s_waitcnt lgkmcnt(0)
    v_mfma_f32_16x16x32_bf16 v[160:163], v[232:235], v[148:151], v[160:163]
    v_mfma_f32_16x16x32_bf16 v[172:175], v[232:235], v[152:155], v[172:175]
    v_mfma_f32_16x16x32_bf16 v[184:187], v[232:235], v[156:159], v[184:187]
    v_mfma_f32_16x16x32_bf16 v[164:167], v[236:239], v[148:151], v[164:167]
    v_mfma_f32_16x16x32_bf16 v[176:179], v[236:239], v[152:155], v[176:179]
    v_mfma_f32_16x16x32_bf16 v[188:191], v[236:239], v[156:159], v[188:191]
    v_mfma_f32_16x16x32_bf16 v[168:171], v[240:243], v[148:151], v[168:171]
    v_mfma_f32_16x16x32_bf16 v[180:183], v[240:243], v[152:155], v[180:183]
    v_mfma_f32_16x16x32_bf16 v[192:195], v[240:243], v[156:159], v[192:195]
    v_mfma_f32_16x16x32_bf16 v[196:199], v[240:243], v[244:247], v[196:199]
    v_lshlrev_b32 v70, 16, v31
    v_and_b32 v71, s66, v31
    v_lshlrev_b32 v72, 16, v32
    v_and_b32 v73, s66, v32
    v_lshlrev_b32 v74, 16, v33
    v_and_b32 v75, s66, v33
    v_lshlrev_b32 v76, 16, v34
    v_and_b32 v77, s66, v34
    v_lshlrev_b32 v78, 16, v35
    v_and_b32 v79, s66, v35
    s_branch L_epi
L_epi:
    s_nop 7
    v_pk_add_f32 v[160:161], v[160:161], v[40:41]
    v_pk_add_f32 v[162:163], v[162:163], v[42:43]
    v_pk_add_f32 v[164:165], v[164:165], v[44:45]
    v_pk_add_f32 v[166:167], v[166:167], v[46:47]
    v_pk_add_f32 v[168:169], v[168:169], v[48:49]
    v_pk_add_f32 v[170:171], v[170:171], v[50:51]
    v_cvt_pk_bf16_f32 v232, v160, v161
    v_cvt_pk_bf16_f32 v233, v162, v163
    v_cvt_pk_bf16_f32 v234, v164, v165
    v_cvt_pk_bf16_f32 v235, v166, v167
    v_cvt_pk_bf16_f32 v236, v168, v169
    v_cvt_pk_bf16_f32 v237, v170, v171
    buffer_store_dwordx4 v[232:235], v12, s[48:51], 0 offen
    buffer_store_dwordx2 v[236:237], v12, s[48:51], 0 offen offset:16
    v_pk_add_f32 v[172:173], v[172:173], v[52:53]
    v_pk_add_f32 v[174:175], v[174:175], v[54:55]
    v_pk_add_f32 v[176:177], v[176:177], v[56:57]
    v_pk_add_f32 v[178:179], v[178:179], v[58:59]
    v_pk_add_f32 v[180:181], v[180:181], v[60:61]
    v_pk_add_f32 v[182:183], v[182:183], v[62:63]
    v_cvt_pk_bf16_f32 v238, v172, v173
    v_cvt_pk_bf16_f32 v239, v174, v175
    v_cvt_pk_bf16_f32 v240, v176, v177
    v_cvt_pk_bf16_f32 v241, v178, v179
    v_cvt_pk_bf16_f32 v242, v180, v181
    v_cvt_pk_bf16_f32 v243, v182, v183
    buffer_store_dwordx4 v[238:241], v13, s[48:51], 0 offen
    buffer_store_dwordx2 v[242:243], v13, s[48:51], 0 offen offset:16
    v_pk_add_f32 v[184:185], v[184:185], v[64:65]
    v_pk_add_f32 v[186:187], v[186:187], v[66:67]
    v_pk_add_f32 v[188:189], v[188:189], v[68:69]
    v_pk_add_f32 v[190:191], v[190:191], v[70:71]
    v_pk_add_f32 v[192:193], v[192:193], v[72:73]
    v_pk_add_f32 v[194:195], v[194:195], v[74:75]
    v_cvt_pk_bf16_f32 v244, v184, v185
    v_cvt_pk_bf16_f32 v245, v186, v187
    v_cvt_pk_bf16_f32 v246, v188, v189
    v_cvt_pk_bf16_f32 v247, v190, v191
    v_cvt_pk_bf16_f32 v248, v192, v193
    v_cvt_pk_bf16_f32 v249, v194, v195
    buffer_store_dwordx4 v[244:247], v14, s[48:51], 0 offen
    buffer_store_dwordx2 v[248:249], v14, s[48:51], 0 offen offset:16
    v_pk_add_f32 v[196:197], v[196:197], v[76:77]
    v_pk_add_f32 v[198:199], v[198:199], v[78:79]
    v_cvt_pk_bf16_f32 v250, v196, v197
    v_cvt_pk_bf16_f32 v251, v198, v199
    s_cmp_eq_u32 s62, 3
    s_cbranch_scc1 L_fin
    buffer_store_dwordx2 v[250:251], v15, s[48:51], 0 offen
L_fin:
L_end:
    s_endpgm
.section .rodata,"a"
.p2align 6
.amdhsa_kernel standalone__modern_conv_block_convnext_v2__vision_kernel
  .amdhsa_next_free_vgpr 256
  .amdhsa_next_free_sgpr 102
  .amdhsa_accum_offset 256
  .amdhsa_group_segment_fixed_size 0
  .amdhsa_kernarg_size 72
  .amdhsa_user_sgpr_count 2
  .amdhsa_user_sgpr_kernarg_segment_ptr 1
  .amdhsa_system_sgpr_workgroup_id_x 1
.end_amdhsa_kernel
```
